```python
import torch

def _softmax(x, axis=-1):
    return torch.softmax(x, dim=axis)
def _gelu(x):
    return torch.nn.functional.gelu(x, approximate="tanh")
def _silu(x):
    return torch.nn.functional.silu(x)
def _sigmoid(x):
    return torch.sigmoid(x)
def _layernorm(x, axis=-1, eps=1e-5):
    m = x.mean(dim=axis, keepdim=True)
    v = x.var(dim=axis, keepdim=True, unbiased=False)
    return (x - m) / torch.sqrt(v + eps)
def _scatter_add(tgt, idx, src, axis=0):
    return tgt.clone().index_add_(axis, idx, src)
def _segment_sum(src, seg, n):
    out = torch.zeros((n,) + src.shape[1:], dtype=src.dtype)
    return out.index_add_(0, seg, src)
def _pad(x, pw):
    flat = tuple(v for pair in reversed(pw) for v in pair)
    return torch.nn.functional.pad(x, flat)

kernel_name = 'interleave_layers__sliding_local_dilated__dense_activation_silu__prompt'

def setup_inputs():

    _w = (lambda a: (lambda t: t.to(torch.bfloat16) if t.is_floating_point() else t)(torch.as_tensor(a)))
    def _A_setup():
        B, S, D = 1, 2048, 512
        return {
            "x": _w((lambda *s: torch.randn(*s, dtype=torch.bfloat16) * 0.05)(B, S, D)),
            "wqkv": _w((lambda *s: torch.randn(*s, dtype=torch.bfloat16) * 0.05)(D, 3 * D)),
            "wo": _w((lambda *s: torch.randn(*s, dtype=torch.bfloat16) * 0.05)(D, D)),
        }
    _A_in = _A_setup()

    def _B_setup():
        B, S, D, F = 1, 2048, 512, 1792
        return {
            "x": _w((lambda *s: torch.randn(*s, dtype=torch.bfloat16) * 0.05)(B, S, D)),
            "w1": _w((lambda *s: torch.randn(*s, dtype=torch.bfloat16) * 0.8)(D, F) * (D ** -0.5)),
            "w2": _w((lambda *s: torch.randn(*s, dtype=torch.bfloat16) * 0.8)(F, D) * (F ** -0.5)),
        }
    _B_in = _B_setup()

    return {
        "A_x": _A_in["x"],
        "A_wqkv": _A_in["wqkv"],
        "A_wo": _A_in["wo"],
        "B_x": _B_in["x"],
        "B_w1": _B_in["w1"],
        "B_w2": _B_in["w2"],
    }

def reference(A_x, A_wqkv, A_wo, B_x, B_w1, B_w2):
    def _A_ref(x, wqkv, wo):
        B, S, D = x.shape
        H = 32; Dh = D // H
        W, dil = 8, 2
        qkv = (lambda x, *d: x.permute(*d))((x @ wqkv).reshape(B, S, 3, H, Dh), 2, 0, 3, 1, 4)
        q, k, v = qkv[0], qkv[1], qkv[2]
        scale = Dh ** -0.5
        pos = torch.arange(S)
        off = torch.arange(W) * dil
        idx = pos[:, None] - off[None, :]
        mask = idx >= 0
        idx_c = torch.where(mask, idx, 0).reshape(-1)
        kg = k[:, :, idx_c, :].reshape(B, H, S, W, Dh)
        vg = v[:, :, idx_c, :].reshape(B, H, S, W, Dh)
        logits = torch.einsum("bhsd,bhswd->bhsw", q, kg) * scale
        logits = torch.where(mask[None, None, :, :], logits, -1e9)
        attn = _softmax(logits, axis=-1)
        o = torch.einsum("bhsw,bhswd->bhsd", attn, vg)
        return (lambda x, *d: x.permute(*d))(o, 0, 2, 1, 3).reshape(B, S, D) @ wo

    def _B_ref(x, w1, w2):
        h = torch.einsum("bsd,df->bsf", x, w1)
        h = _silu(h)
        out = torch.einsum("bsf,fd->bsd", h, w2)
        return out

    x = A_x
    x = x + _A_ref(_layernorm(x, axis=-1), A_wqkv, A_wo)
    x = x + _B_ref(_layernorm(x, axis=-1), B_w1, B_w2)
    x = x + _A_ref(_layernorm(x, axis=-1), A_wqkv, A_wo)
    x = x + _B_ref(_layernorm(x, axis=-1), B_w1, B_w2)
    return x
```

```asm
; @launch grid=(256,1,1) block=(512,1,1) lds=163840
.amdgcn_target "amdgcn-amd-amdhsa--gfx950"
.text
.globl interleave_layers__sliding_local_dilated__dense_activation_silu__prompt_kernel
.p2align 8
.type interleave_layers__sliding_local_dilated__dense_activation_silu__prompt_kernel,@function
interleave_layers__sliding_local_dilated__dense_activation_silu__prompt_kernel:
    s_cmp_ge_u32 s2, 256
    s_cbranch_scc1 end_all
    s_load_dwordx16 s[36:51], s[0:1], 0
    s_load_dwordx2 s[52:53], s[0:1], 64
    v_lshrrev_b32 v2, 6, v0
    v_and_b32 v1, 63, v0
    v_readfirstlane_b32 s3, v2
    s_and_b32 s4, s2, 7
    s_lshr_b32 s5, s2, 3
    s_mov_b32 s15, 0x3f803f80
    s_waitcnt lgkmcnt(0)
    s_mov_b32 s100, 0
    s_mov_b32 s101, 0
    v_mov_b32 v15, 0
    s_lshr_b32 s10, s5, 3
    s_lshl_b32 s6, s4, 2
    s_add_u32 s10, s10, s6
    s_and_b32 s11, s5, 7
    s_and_b32 s12, s3, 3
    s_lshr_b32 s13, s3, 2
    s_mov_b32 s20, s38
    s_mov_b32 s21, s39
    s_mov_b32 s22, 0x180000
    s_mov_b32 s23, 0x20000
    v_lshrrev_b32 v9, 3, v1
    s_mov_b32 s6, 3072
    v_mul_lo_u32 v209, v9, s6
    v_bfe_u32 v9, v1, 4, 1
    v_lshlrev_b32 v9, 2, v9
    v_and_b32 v10, 7, v1
    v_xor_b32 v9, v9, v10
    v_lshl_add_u32 v209, v9, 4, v209
    s_lshl_b32 s6, s11, 7
    v_add_u32 v209, s6, v209
    v_lshrrev_b32 v9, 3, v1
    v_lshrrev_b32 v10, 4, v1
    v_and_b32 v11, 7, v1
    v_xor_b32 v10, v10, v11
    v_lshlrev_b32 v10, 4, v10
    v_lshl_add_u32 v210, v9, 10, v10
    s_mul_i32 s6, s3, 3
    s_add_u32 s6, s6, 0
    s_lshl_b32 s56, s6, 10
    s_add_u32 s56, s56, 10240
    s_and_b32 s7, s6, 1
    s_lshl_b32 s7, s7, 5
    v_xor_b32 v200, s7, v209
    s_and_b32 s7, s6, 7
    s_mul_i32 s7, s7, 24576
    s_lshr_b32 s6, s6, 3
    s_lshl_b32 s6, s6, 10
    s_add_u32 s6, s6, s7
    v_add_u32 v200, s6, v200
    s_mul_i32 s6, s3, 3
    s_add_u32 s6, s6, 1
    s_lshl_b32 s57, s6, 10
    s_add_u32 s57, s57, 10240
    s_and_b32 s7, s6, 1
    s_lshl_b32 s7, s7, 5
    v_xor_b32 v201, s7, v209
    s_and_b32 s7, s6, 7
    s_mul_i32 s7, s7, 24576
    s_lshr_b32 s6, s6, 3
    s_lshl_b32 s6, s6, 10
    s_add_u32 s6, s6, s7
    v_add_u32 v201, s6, v201
    s_mul_i32 s6, s3, 3
    s_add_u32 s6, s6, 2
    s_lshl_b32 s58, s6, 10
    s_add_u32 s58, s58, 10240
    s_and_b32 s7, s6, 1
    s_lshl_b32 s7, s7, 5
    v_xor_b32 v202, s7, v209
    s_and_b32 s7, s6, 7
    s_mul_i32 s7, s7, 24576
    s_lshr_b32 s6, s6, 3
    s_lshl_b32 s6, s6, 10
    s_add_u32 s6, s6, s7
    v_add_u32 v202, s6, v202
    s_add_u32 m0, s56, 0x0
    s_nop 0
    buffer_load_dwordx4 v200, s[20:23], 0 offen lds
    s_add_u32 m0, s57, 0x0
    s_nop 0
    buffer_load_dwordx4 v201, s[20:23], 0 offen lds
    s_add_u32 m0, s58, 0x0
    s_nop 0
    buffer_load_dwordx4 v202, s[20:23], 0 offen lds
    s_mov_b32 s24, s50
    s_mov_b32 s25, s51
    s_mov_b32 s26, 0x100
    s_mov_b32 s27, 0x20000
    s_add_u32 s96, s52, 0x2800000
    s_addc_u32 s97, s53, 0
    s_mov_b32 s98, 0x4000
    s_mov_b32 s99, 0x20000
layer:
    s_lshr_b32 s10, s5, 3
    s_lshl_b32 s6, s4, 2
    s_add_u32 s10, s10, s6
    s_and_b32 s11, s5, 7
    s_and_b32 s12, s3, 3
    s_lshr_b32 s13, s3, 2
    s_add_u32 s16, s52, 0xc00000
    s_addc_u32 s17, s53, 0
    s_mov_b32 s18, 0x400000
    s_mov_b32 s19, 0x20000
    s_cmp_lg_u32 s100, 0
    s_cbranch_scc1 ifl_1
    s_mov_b32 s16, s36
    s_mov_b32 s17, s37
    s_mov_b32 s18, 0x200000
    s_mov_b32 s19, 0x20000
ifl_1:
    s_mov_b32 s28, s52
    s_mov_b32 s29, s53
    s_mov_b32 s30, 0x200000
    s_mov_b32 s31, 0x20000
    s_cmp_lt_u32 s5, 8
    s_cselect_b32 s65, s4, 0
    s_mul_i32 s65, s65, s100
    s_and_b32 s68, s5, 24
    s_max_u32 s6, s68, 8
    s_sub_u32 s6, s6, 8
    s_lshl_b32 s6, s6, 2
    s_lshl_b32 s7, s4, 7
    s_add_u32 s6, s6, s7
    s_add_u32 s6, s6, 3072
    s_add_u32 s7, s7, 7040
    s_cmp_lg_u32 s65, 0
    s_cselect_b32 s69, s7, s6
    s_lshl_b32 s62, s3, 10
    s_and_b32 s7, s3, 1
    s_lshl_b32 s7, s7, 6
    v_xor_b32 v206, s7, v210
    s_lshl_b32 s6, s10, 16
    s_lshl_b32 s7, s3, 13
    s_add_u32 s6, s6, s7
    s_sub_u32 s6, s6, 0x4000
    s_lshl_b32 s8, s4, 14
    s_add_u32 s8, s8, s7
    s_add_u32 s8, s8, 3129344
    s_cmp_lt_u32 s3, 2
    s_cselect_b32 s7, s65, 0
    s_cmp_lg_u32 s7, 0
    s_cselect_b32 s6, s8, s6
    v_add_u32 v206, s6, v206
    s_cmp_lg_u32 s100, 1
    s_cbranch_scc1 ifl_5
    s_cmp_lg_u32 s3, 0
    s_cbranch_scc1 nopoll_6
    s_lshl_b32 s6, s4, 7
    s_lshl_b32 s7, s68, 2
    s_add_u32 s6, s6, s7
    s_add_u32 s6, s6, 3072
    v_min_u32 v2, 7, v1
    v_lshl_add_u32 v2, v2, 2, s6
    s_cmp_lg_u32 s65, 0
    s_cselect_b32 s7, 31, 7
    v_and_b32 v3, s7, v1
    v_lshl_add_u32 v3, v3, 2, s69
    v_cmp_gt_u32 vcc, 32, v1
    s_nop 1
    v_cndmask_b32 v2, v3, v2, vcc
    s_mov_b32 s9, 0
spin_7:
    buffer_load_dword v3, v2, s[96:99], 0 offen sc1
    s_waitcnt vmcnt(0)
    v_cmp_ne_u32 vcc, s55, v3
    s_add_u32 s9, s9, 1
    s_cmp_gt_u32 s9, 0x40000
    s_cbranch_scc1 spun_8
    s_cbranch_vccnz spin_7
spun_8:
    s_cmp_lg_u32 s54, 0
    s_cbranch_scc1 nopoll_6
    buffer_inv sc1
    s_waitcnt vmcnt(0)
nopoll_6:
    s_barrier
ifl_5:
    s_cmp_ge_u32 s3, 4
    s_cbranch_scc1 p1l_3
    s_add_u32 m0, s62, 0x0
    s_nop 0
    buffer_load_dwordx4 v206, s[16:19], 0 offen sc1 lds
    s_cmp_lg_u32 s100, 0
    s_cbranch_scc1 ifl_9
    s_add_u32 m0, s56, 0x8800
    s_mov_b32 s9, 0x30000
    buffer_load_dwordx4 v200, s[20:23], s9 offen lds
    s_add_u32 m0, s57, 0x8800
    s_mov_b32 s9, 0x30000
    buffer_load_dwordx4 v201, s[20:23], s9 offen lds
    s_add_u32 m0, s58, 0x8800
    s_mov_b32 s9, 0x30000
    buffer_load_dwordx4 v202, s[20:23], s9 offen lds
ifl_9:
    s_add_u32 m0, s62, 0x8800
    s_mov_b32 s9, 0x80
    buffer_load_dwordx4 v206, s[16:19], s9 offen sc1 lds
    s_cmp_lg_u32 s100, 0
    s_cbranch_scc1 ifl_10
    s_add_u32 m0, s56, 0x11000
    s_mov_b32 s9, 0x60000
    buffer_load_dwordx4 v200, s[20:23], s9 offen lds
    s_add_u32 m0, s57, 0x11000
    s_mov_b32 s9, 0x60000
    buffer_load_dwordx4 v201, s[20:23], s9 offen lds
    s_add_u32 m0, s58, 0x11000
    s_mov_b32 s9, 0x60000
    buffer_load_dwordx4 v202, s[20:23], s9 offen lds
ifl_10:
    s_add_u32 m0, s62, 0x11000
    s_mov_b32 s9, 0x100
    buffer_load_dwordx4 v206, s[16:19], s9 offen sc1 lds
    s_cmp_eq_u32 s3, 3
    s_cbranch_scc1 p1h_2
    s_setprio 1
    v_and_b32 v9, 31, v1
    v_lshrrev_b32 v10, 5, v1
    v_add_u32 v9, 16, v9
    v_bfe_u32 v11, v9, 1, 3
    v_xor_b32 v10, v10, v11
    v_lshlrev_b32 v10, 4, v10
    v_lshl_add_u32 v2, v9, 7, v10
    v_xor_b32 v3, 32, v2
    v_xor_b32 v4, 64, v2
    v_xor_b32 v5, 96, v2
    v_bfe_u32 v9, v1, 2, 2
    v_lshrrev_b32 v10, 5, v1
    v_lshl_add_u32 v6, v10, 3, v9
    v_lshlrev_b32 v6, 7, v6
    v_lshrrev_b32 v9, 1, v9
    v_lshlrev_b32 v9, 2, v9
    v_lshl_or_b32 v9, v10, 1, v9
    v_and_b32 v10, 1, v1
    v_bfe_u32 v11, v1, 4, 1
    v_lshl_or_b32 v10, v10, 1, v11
    v_bfe_u32 v11, v1, 1, 1
    v_xor_b32 v9, v9, v10
    v_lshl_add_u32 v6, v9, 4, v6
    v_lshl_add_u32 v6, v11, 3, v6
    s_min_u32 s66, s3, 1
    s_lshr_b32 s67, s3, 1
    s_lshl_b32 s68, s66, 1
    s_and_b32 s69, s3, 1
    s_xor_b32 s69, s69, 1
    s_lshl_b32 s6, s69, 6
    v_xor_b32 v7, s6, v6
    s_lshl_b32 s6, s68, 13
    s_add_u32 s6, s6, 10240
    v_add_u32 v7, s6, v7
    s_lshl_b32 s6, s67, 6
    v_xor_b32 v6, s6, v6
    s_lshl_b32 s6, s66, 13
    s_add_u32 s6, s6, 10240
    v_add_u32 v6, s6, v6
    s_cmp_eq_u32 s100, 0
    s_cbranch_scc1 w0_11
    s_waitcnt vmcnt(2)
    s_branch w1_12
w0_11:
    s_waitcnt vmcnt(8)
w1_12:
    s_barrier
    ds_read_b64_tr_b16 v[104:105], v6 offset:0
    ds_read_b64_tr_b16 v[106:107], v6 offset:512
    ds_read_b128 v[96:99], v2
    ds_read_b128 v[100:103], v2 offset:4096
    ds_read_b64_tr_b16 v[108:109], v7 offset:0
    ds_read_b64_tr_b16 v[110:111], v7 offset:512
    ds_read_b64_tr_b16 v[120:121], v6 offset:2048
    ds_read_b64_tr_b16 v[122:123], v6 offset:2560
    s_waitcnt lgkmcnt(5)
    v_mfma_f32_32x32x16_bf16 v[32:47], v[104:107], v[96:99], 0
    ds_read_b128 v[112:115], v3
    ds_read_b128 v[116:119], v3 offset:4096
    s_waitcnt lgkmcnt(6)
    v_mfma_f32_32x32x16_bf16 v[48:63], v[104:107], v[100:103], 0
    ds_read_b64_tr_b16 v[124:125], v7 offset:2048
    ds_read_b64_tr_b16 v[126:127], v7 offset:2560
    s_waitcnt lgkmcnt(6)
    v_mfma_f32_32x32x16_bf16 v[64:79], v[108:111], v[96:99], 0
    v_mfma_f32_32x32x16_bf16 v[80:95], v[108:111], v[100:103], 0
    ds_read_b64_tr_b16 v[104:105], v6 offset:4096
    ds_read_b64_tr_b16 v[106:107], v6 offset:4608
    s_waitcnt lgkmcnt(5)
    v_mfma_f32_32x32x16_bf16 v[32:47], v[120:123], v[112:115], v[32:47]
    ds_read_b128 v[96:99], v4
    ds_read_b128 v[100:103], v4 offset:4096
    s_waitcnt lgkmcnt(6)
    v_mfma_f32_32x32x16_bf16 v[48:63], v[120:123], v[116:119], v[48:63]
    ds_read_b64_tr_b16 v[108:109], v7 offset:4096
    ds_read_b64_tr_b16 v[110:111], v7 offset:4608
    s_waitcnt lgkmcnt(6)
    v_mfma_f32_32x32x16_bf16 v[64:79], v[124:127], v[112:115], v[64:79]
    v_mfma_f32_32x32x16_bf16 v[80:95], v[124:127], v[116:119], v[80:95]
    ds_read_b64_tr_b16 v[120:121], v6 offset:6144
    ds_read_b64_tr_b16 v[122:123], v6 offset:6656
    s_waitcnt lgkmcnt(5)
    v_mfma_f32_32x32x16_bf16 v[32:47], v[104:107], v[96:99], v[32:47]
    ds_read_b128 v[112:115], v5
    ds_read_b128 v[116:119], v5 offset:4096
    s_waitcnt lgkmcnt(6)
    v_mfma_f32_32x32x16_bf16 v[48:63], v[104:107], v[100:103], v[48:63]
    ds_read_b64_tr_b16 v[124:125], v7 offset:6144
    ds_read_b64_tr_b16 v[126:127], v7 offset:6656
    s_waitcnt lgkmcnt(6)
    v_mfma_f32_32x32x16_bf16 v[64:79], v[108:111], v[96:99], v[64:79]
    v_mfma_f32_32x32x16_bf16 v[80:95], v[108:111], v[100:103], v[80:95]
    s_cmp_eq_u32 s100, 0
    s_cbranch_scc1 w0_13
    s_waitcnt vmcnt(1)
    s_branch w1_14
w0_13:
    s_waitcnt vmcnt(4)
w1_14:
    s_waitcnt lgkmcnt(0)
    v_add_u32 v2, 0x8800, v2
    v_add_u32 v3, 0x8800, v3
    v_add_u32 v4, 0x8800, v4
    v_add_u32 v5, 0x8800, v5
    v_add_u32 v6, 0x8800, v6
    v_add_u32 v7, 0x8800, v7
    s_barrier
    ds_read_b64_tr_b16 v[104:105], v6 offset:0
    ds_read_b64_tr_b16 v[106:107], v6 offset:512
    v_mfma_f32_32x32x16_bf16 v[32:47], v[120:123], v[112:115], v[32:47]
    ds_read_b128 v[96:99], v2
    ds_read_b128 v[100:103], v2 offset:4096
    v_mfma_f32_32x32x16_bf16 v[48:63], v[120:123], v[116:119], v[48:63]
    ds_read_b64_tr_b16 v[108:109], v7 offset:0
    ds_read_b64_tr_b16 v[110:111], v7 offset:512
    v_mfma_f32_32x32x16_bf16 v[64:79], v[124:127], v[112:115], v[64:79]
    v_mfma_f32_32x32x16_bf16 v[80:95], v[124:127], v[116:119], v[80:95]
    ds_read_b64_tr_b16 v[120:121], v6 offset:2048
    ds_read_b64_tr_b16 v[122:123], v6 offset:2560
    s_waitcnt lgkmcnt(5)
    v_mfma_f32_32x32x16_bf16 v[32:47], v[104:107], v[96:99], v[32:47]
    ds_read_b128 v[112:115], v3
    ds_read_b128 v[116:119], v3 offset:4096
    s_waitcnt lgkmcnt(6)
    v_mfma_f32_32x32x16_bf16 v[48:63], v[104:107], v[100:103], v[48:63]
    ds_read_b64_tr_b16 v[124:125], v7 offset:2048
    ds_read_b64_tr_b16 v[126:127], v7 offset:2560
    s_waitcnt lgkmcnt(6)
    v_mfma_f32_32x32x16_bf16 v[64:79], v[108:111], v[96:99], v[64:79]
    v_mfma_f32_32x32x16_bf16 v[80:95], v[108:111], v[100:103], v[80:95]
    ds_read_b64_tr_b16 v[104:105], v6 offset:4096
    ds_read_b64_tr_b16 v[106:107], v6 offset:4608
    s_waitcnt lgkmcnt(5)
    v_mfma_f32_32x32x16_bf16 v[32:47], v[120:123], v[112:115], v[32:47]
    ds_read_b128 v[96:99], v4
    ds_read_b128 v[100:103], v4 offset:4096
    s_waitcnt lgkmcnt(6)
    v_mfma_f32_32x32x16_bf16 v[48:63], v[120:123], v[116:119], v[48:63]
    ds_read_b64_tr_b16 v[108:109], v7 offset:4096
    ds_read_b64_tr_b16 v[110:111], v7 offset:4608
    s_waitcnt lgkmcnt(6)
    v_mfma_f32_32x32x16_bf16 v[64:79], v[124:127], v[112:115], v[64:79]
    v_mfma_f32_32x32x16_bf16 v[80:95], v[124:127], v[116:119], v[80:95]
    ds_read_b64_tr_b16 v[120:121], v6 offset:6144
    ds_read_b64_tr_b16 v[122:123], v6 offset:6656
    s_waitcnt lgkmcnt(5)
    v_mfma_f32_32x32x16_bf16 v[32:47], v[104:107], v[96:99], v[32:47]
    ds_read_b128 v[112:115], v5
    ds_read_b128 v[116:119], v5 offset:4096
    s_waitcnt lgkmcnt(6)
    v_mfma_f32_32x32x16_bf16 v[48:63], v[104:107], v[100:103], v[48:63]
    ds_read_b64_tr_b16 v[124:125], v7 offset:6144
    ds_read_b64_tr_b16 v[126:127], v7 offset:6656
    s_waitcnt lgkmcnt(6)
    v_mfma_f32_32x32x16_bf16 v[64:79], v[108:111], v[96:99], v[64:79]
    v_mfma_f32_32x32x16_bf16 v[80:95], v[108:111], v[100:103], v[80:95]
    s_waitcnt vmcnt(0)
    s_waitcnt lgkmcnt(0)
    v_add_u32 v2, 0x8800, v2
    v_add_u32 v3, 0x8800, v3
    v_add_u32 v4, 0x8800, v4
    v_add_u32 v5, 0x8800, v5
    v_add_u32 v6, 0x8800, v6
    v_add_u32 v7, 0x8800, v7
    s_barrier
    ds_read_b64_tr_b16 v[104:105], v6 offset:0
    ds_read_b64_tr_b16 v[106:107], v6 offset:512
    v_mfma_f32_32x32x16_bf16 v[32:47], v[120:123], v[112:115], v[32:47]
    ds_read_b128 v[96:99], v2
    ds_read_b128 v[100:103], v2 offset:4096
    v_mfma_f32_32x32x16_bf16 v[48:63], v[120:123], v[116:119], v[48:63]
    ds_read_b64_tr_b16 v[108:109], v7 offset:0
    ds_read_b64_tr_b16 v[110:111], v7 offset:512
    v_mfma_f32_32x32x16_bf16 v[64:79], v[124:127], v[112:115], v[64:79]
    v_mfma_f32_32x32x16_bf16 v[80:95], v[124:127], v[116:119], v[80:95]
    ds_read_b64_tr_b16 v[120:121], v6 offset:2048
    ds_read_b64_tr_b16 v[122:123], v6 offset:2560
    s_waitcnt lgkmcnt(5)
    v_mfma_f32_32x32x16_bf16 v[32:47], v[104:107], v[96:99], v[32:47]
    ds_read_b128 v[112:115], v3
    ds_read_b128 v[116:119], v3 offset:4096
    s_waitcnt lgkmcnt(6)
    v_mfma_f32_32x32x16_bf16 v[48:63], v[104:107], v[100:103], v[48:63]
    ds_read_b64_tr_b16 v[124:125], v7 offset:2048
    ds_read_b64_tr_b16 v[126:127], v7 offset:2560
    s_waitcnt lgkmcnt(6)
    v_mfma_f32_32x32x16_bf16 v[64:79], v[108:111], v[96:99], v[64:79]
    v_mfma_f32_32x32x16_bf16 v[80:95], v[108:111], v[100:103], v[80:95]
    ds_read_b64_tr_b16 v[104:105], v6 offset:4096
    ds_read_b64_tr_b16 v[106:107], v6 offset:4608
    s_waitcnt lgkmcnt(5)
    v_mfma_f32_32x32x16_bf16 v[32:47], v[120:123], v[112:115], v[32:47]
    ds_read_b128 v[96:99], v4
    ds_read_b128 v[100:103], v4 offset:4096
    s_waitcnt lgkmcnt(6)
    v_mfma_f32_32x32x16_bf16 v[48:63], v[120:123], v[116:119], v[48:63]
    ds_read_b64_tr_b16 v[108:109], v7 offset:4096
    ds_read_b64_tr_b16 v[110:111], v7 offset:4608
    s_waitcnt lgkmcnt(6)
    v_mfma_f32_32x32x16_bf16 v[64:79], v[124:127], v[112:115], v[64:79]
    v_mfma_f32_32x32x16_bf16 v[80:95], v[124:127], v[116:119], v[80:95]
    ds_read_b64_tr_b16 v[120:121], v6 offset:6144
    ds_read_b64_tr_b16 v[122:123], v6 offset:6656
    s_waitcnt lgkmcnt(5)
    v_mfma_f32_32x32x16_bf16 v[32:47], v[104:107], v[96:99], v[32:47]
    ds_read_b128 v[112:115], v5
    ds_read_b128 v[116:119], v5 offset:4096
    s_waitcnt lgkmcnt(6)
    v_mfma_f32_32x32x16_bf16 v[48:63], v[104:107], v[100:103], v[48:63]
    ds_read_b64_tr_b16 v[124:125], v7 offset:6144
    ds_read_b64_tr_b16 v[126:127], v7 offset:6656
    s_waitcnt lgkmcnt(6)
    v_mfma_f32_32x32x16_bf16 v[64:79], v[108:111], v[96:99], v[64:79]
    v_mfma_f32_32x32x16_bf16 v[80:95], v[108:111], v[100:103], v[80:95]
    s_waitcnt lgkmcnt(0)
    v_add_u32 v2, 0x8800, v2
    v_add_u32 v3, 0x8800, v3
    v_add_u32 v4, 0x8800, v4
    v_add_u32 v5, 0x8800, v5
    v_add_u32 v6, 0x8800, v6
    v_add_u32 v7, 0x8800, v7
    s_barrier
    ds_read_b64_tr_b16 v[104:105], v6 offset:0
    ds_read_b64_tr_b16 v[106:107], v6 offset:512
    v_mfma_f32_32x32x16_bf16 v[32:47], v[120:123], v[112:115], v[32:47]
    ds_read_b128 v[96:99], v2
    ds_read_b128 v[100:103], v2 offset:4096
    v_mfma_f32_32x32x16_bf16 v[48:63], v[120:123], v[116:119], v[48:63]
    ds_read_b64_tr_b16 v[108:109], v7 offset:0
    ds_read_b64_tr_b16 v[110:111], v7 offset:512
    v_mfma_f32_32x32x16_bf16 v[64:79], v[124:127], v[112:115], v[64:79]
    v_mfma_f32_32x32x16_bf16 v[80:95], v[124:127], v[116:119], v[80:95]
    ds_read_b64_tr_b16 v[120:121], v6 offset:2048
    ds_read_b64_tr_b16 v[122:123], v6 offset:2560
    s_waitcnt lgkmcnt(5)
    v_mfma_f32_32x32x16_bf16 v[32:47], v[104:107], v[96:99], v[32:47]
    ds_read_b128 v[112:115], v3
    ds_read_b128 v[116:119], v3 offset:4096
    s_waitcnt lgkmcnt(6)
    v_mfma_f32_32x32x16_bf16 v[48:63], v[104:107], v[100:103], v[48:63]
    ds_read_b64_tr_b16 v[124:125], v7 offset:2048
    ds_read_b64_tr_b16 v[126:127], v7 offset:2560
    s_waitcnt lgkmcnt(6)
    v_mfma_f32_32x32x16_bf16 v[64:79], v[108:111], v[96:99], v[64:79]
    v_mfma_f32_32x32x16_bf16 v[80:95], v[108:111], v[100:103], v[80:95]
    ds_read_b64_tr_b16 v[104:105], v6 offset:4096
    ds_read_b64_tr_b16 v[106:107], v6 offset:4608
    s_waitcnt lgkmcnt(5)
    v_mfma_f32_32x32x16_bf16 v[32:47], v[120:123], v[112:115], v[32:47]
    ds_read_b128 v[96:99], v4
    ds_read_b128 v[100:103], v4 offset:4096
    s_waitcnt lgkmcnt(6)
    v_mfma_f32_32x32x16_bf16 v[48:63], v[120:123], v[116:119], v[48:63]
    ds_read_b64_tr_b16 v[108:109], v7 offset:4096
    ds_read_b64_tr_b16 v[110:111], v7 offset:4608
    s_waitcnt lgkmcnt(6)
    v_mfma_f32_32x32x16_bf16 v[64:79], v[124:127], v[112:115], v[64:79]
    v_mfma_f32_32x32x16_bf16 v[80:95], v[124:127], v[116:119], v[80:95]
    ds_read_b64_tr_b16 v[120:121], v6 offset:6144
    ds_read_b64_tr_b16 v[122:123], v6 offset:6656
    s_waitcnt lgkmcnt(5)
    v_mfma_f32_32x32x16_bf16 v[32:47], v[104:107], v[96:99], v[32:47]
    ds_read_b128 v[112:115], v5
    ds_read_b128 v[116:119], v5 offset:4096
    s_waitcnt lgkmcnt(6)
    v_mfma_f32_32x32x16_bf16 v[48:63], v[104:107], v[100:103], v[48:63]
    ds_read_b64_tr_b16 v[124:125], v7 offset:6144
    ds_read_b64_tr_b16 v[126:127], v7 offset:6656
    s_waitcnt lgkmcnt(6)
    v_mfma_f32_32x32x16_bf16 v[64:79], v[108:111], v[96:99], v[64:79]
    v_mfma_f32_32x32x16_bf16 v[80:95], v[108:111], v[100:103], v[80:95]
    s_waitcnt lgkmcnt(0)
    v_add_u32 v2, 0xfffe6800, v2
    v_add_u32 v3, 0xfffe6800, v3
    v_add_u32 v4, 0xfffe6800, v4
    v_add_u32 v5, 0xfffe6800, v5
    v_add_u32 v6, 0xfffe6800, v6
    v_add_u32 v7, 0xfffe6800, v7
    s_barrier
    ds_read_b64_tr_b16 v[104:105], v6 offset:0
    ds_read_b64_tr_b16 v[106:107], v6 offset:512
    v_mfma_f32_32x32x16_bf16 v[32:47], v[120:123], v[112:115], v[32:47]
    ds_read_b128 v[96:99], v2
    ds_read_b128 v[100:103], v2 offset:4096
    v_mfma_f32_32x32x16_bf16 v[48:63], v[120:123], v[116:119], v[48:63]
    ds_read_b64_tr_b16 v[108:109], v7 offset:0
    ds_read_b64_tr_b16 v[110:111], v7 offset:512
    v_mfma_f32_32x32x16_bf16 v[64:79], v[124:127], v[112:115], v[64:79]
    v_mfma_f32_32x32x16_bf16 v[80:95], v[124:127], v[116:119], v[80:95]
    ds_read_b64_tr_b16 v[120:121], v6 offset:2048
    ds_read_b64_tr_b16 v[122:123], v6 offset:2560
    s_waitcnt lgkmcnt(5)
    v_mfma_f32_32x32x16_bf16 v[32:47], v[104:107], v[96:99], v[32:47]
    ds_read_b128 v[112:115], v3
    ds_read_b128 v[116:119], v3 offset:4096
    s_waitcnt lgkmcnt(6)
    v_mfma_f32_32x32x16_bf16 v[48:63], v[104:107], v[100:103], v[48:63]
    ds_read_b64_tr_b16 v[124:125], v7 offset:2048
    ds_read_b64_tr_b16 v[126:127], v7 offset:2560
    s_waitcnt lgkmcnt(6)
    v_mfma_f32_32x32x16_bf16 v[64:79], v[108:111], v[96:99], v[64:79]
    v_mfma_f32_32x32x16_bf16 v[80:95], v[108:111], v[100:103], v[80:95]
    ds_read_b64_tr_b16 v[104:105], v6 offset:4096
    ds_read_b64_tr_b16 v[106:107], v6 offset:4608
    s_waitcnt lgkmcnt(5)
    v_mfma_f32_32x32x16_bf16 v[32:47], v[120:123], v[112:115], v[32:47]
    ds_read_b128 v[96:99], v4
    ds_read_b128 v[100:103], v4 offset:4096
    s_waitcnt lgkmcnt(6)
    v_mfma_f32_32x32x16_bf16 v[48:63], v[120:123], v[116:119], v[48:63]
    ds_read_b64_tr_b16 v[108:109], v7 offset:4096
    ds_read_b64_tr_b16 v[110:111], v7 offset:4608
    s_waitcnt lgkmcnt(6)
    v_mfma_f32_32x32x16_bf16 v[64:79], v[124:127], v[112:115], v[64:79]
    v_mfma_f32_32x32x16_bf16 v[80:95], v[124:127], v[116:119], v[80:95]
    ds_read_b64_tr_b16 v[120:121], v6 offset:6144
    ds_read_b64_tr_b16 v[122:123], v6 offset:6656
    s_waitcnt lgkmcnt(5)
    v_mfma_f32_32x32x16_bf16 v[32:47], v[104:107], v[96:99], v[32:47]
    ds_read_b128 v[112:115], v5
    ds_read_b128 v[116:119], v5 offset:4096
    s_waitcnt lgkmcnt(6)
    v_mfma_f32_32x32x16_bf16 v[48:63], v[104:107], v[100:103], v[48:63]
    ds_read_b64_tr_b16 v[124:125], v7 offset:6144
    ds_read_b64_tr_b16 v[126:127], v7 offset:6656
    s_waitcnt lgkmcnt(6)
    v_mfma_f32_32x32x16_bf16 v[64:79], v[108:111], v[96:99], v[64:79]
    v_mfma_f32_32x32x16_bf16 v[80:95], v[108:111], v[100:103], v[80:95]
    v_add_u32 v2, 0x8800, v2
    v_add_u32 v3, 0x8800, v3
    v_add_u32 v4, 0x8800, v4
    v_add_u32 v5, 0x8800, v5
    v_add_u32 v6, 0x8800, v6
    v_add_u32 v7, 0x8800, v7
    s_barrier
    ds_read_b64_tr_b16 v[104:105], v6 offset:0
    ds_read_b64_tr_b16 v[106:107], v6 offset:512
    s_waitcnt lgkmcnt(5)
    v_mfma_f32_32x32x16_bf16 v[32:47], v[120:123], v[112:115], v[32:47]
    ds_read_b128 v[96:99], v2
    ds_read_b128 v[100:103], v2 offset:4096
    s_waitcnt lgkmcnt(6)
    v_mfma_f32_32x32x16_bf16 v[48:63], v[120:123], v[116:119], v[48:63]
    ds_read_b64_tr_b16 v[108:109], v7 offset:0
    ds_read_b64_tr_b16 v[110:111], v7 offset:512
    s_waitcnt lgkmcnt(6)
    v_mfma_f32_32x32x16_bf16 v[64:79], v[124:127], v[112:115], v[64:79]
    v_mfma_f32_32x32x16_bf16 v[80:95], v[124:127], v[116:119], v[80:95]
    ds_read_b64_tr_b16 v[120:121], v6 offset:2048
    ds_read_b64_tr_b16 v[122:123], v6 offset:2560
    s_waitcnt lgkmcnt(5)
    v_mfma_f32_32x32x16_bf16 v[32:47], v[104:107], v[96:99], v[32:47]
    ds_read_b128 v[112:115], v3
    ds_read_b128 v[116:119], v3 offset:4096
    s_waitcnt lgkmcnt(6)
    v_mfma_f32_32x32x16_bf16 v[48:63], v[104:107], v[100:103], v[48:63]
    ds_read_b64_tr_b16 v[124:125], v7 offset:2048
    ds_read_b64_tr_b16 v[126:127], v7 offset:2560
    s_waitcnt lgkmcnt(6)
    v_mfma_f32_32x32x16_bf16 v[64:79], v[108:111], v[96:99], v[64:79]
    v_mfma_f32_32x32x16_bf16 v[80:95], v[108:111], v[100:103], v[80:95]
    ds_read_b64_tr_b16 v[104:105], v6 offset:4096
    ds_read_b64_tr_b16 v[106:107], v6 offset:4608
    s_waitcnt lgkmcnt(5)
    v_mfma_f32_32x32x16_bf16 v[32:47], v[120:123], v[112:115], v[32:47]
    ds_read_b128 v[96:99], v4
    ds_read_b128 v[100:103], v4 offset:4096
    s_waitcnt lgkmcnt(6)
    v_mfma_f32_32x32x16_bf16 v[48:63], v[120:123], v[116:119], v[48:63]
    ds_read_b64_tr_b16 v[108:109], v7 offset:4096
    ds_read_b64_tr_b16 v[110:111], v7 offset:4608
    s_waitcnt lgkmcnt(6)
    v_mfma_f32_32x32x16_bf16 v[64:79], v[124:127], v[112:115], v[64:79]
    v_mfma_f32_32x32x16_bf16 v[80:95], v[124:127], v[116:119], v[80:95]
    ds_read_b64_tr_b16 v[120:121], v6 offset:6144
    ds_read_b64_tr_b16 v[122:123], v6 offset:6656
    s_waitcnt lgkmcnt(5)
    v_mfma_f32_32x32x16_bf16 v[32:47], v[104:107], v[96:99], v[32:47]
    ds_read_b128 v[112:115], v5
    ds_read_b128 v[116:119], v5 offset:4096
    s_waitcnt lgkmcnt(6)
    v_mfma_f32_32x32x16_bf16 v[48:63], v[104:107], v[100:103], v[48:63]
    ds_read_b64_tr_b16 v[124:125], v7 offset:6144
    ds_read_b64_tr_b16 v[126:127], v7 offset:6656
    s_waitcnt lgkmcnt(6)
    v_mfma_f32_32x32x16_bf16 v[64:79], v[108:111], v[96:99], v[64:79]
    v_mfma_f32_32x32x16_bf16 v[80:95], v[108:111], v[100:103], v[80:95]
    v_add_u32 v2, 0x8800, v2
    v_add_u32 v3, 0x8800, v3
    v_add_u32 v4, 0x8800, v4
    v_add_u32 v5, 0x8800, v5
    v_add_u32 v6, 0x8800, v6
    v_add_u32 v7, 0x8800, v7
    s_barrier
    ds_read_b64_tr_b16 v[104:105], v6 offset:0
    ds_read_b64_tr_b16 v[106:107], v6 offset:512
    s_waitcnt lgkmcnt(5)
    v_mfma_f32_32x32x16_bf16 v[32:47], v[120:123], v[112:115], v[32:47]
    ds_read_b128 v[96:99], v2
    ds_read_b128 v[100:103], v2 offset:4096
    s_waitcnt lgkmcnt(6)
    v_mfma_f32_32x32x16_bf16 v[48:63], v[120:123], v[116:119], v[48:63]
    ds_read_b64_tr_b16 v[108:109], v7 offset:0
    ds_read_b64_tr_b16 v[110:111], v7 offset:512
    s_waitcnt lgkmcnt(6)
    v_mfma_f32_32x32x16_bf16 v[64:79], v[124:127], v[112:115], v[64:79]
    v_mfma_f32_32x32x16_bf16 v[80:95], v[124:127], v[116:119], v[80:95]
    ds_read_b64_tr_b16 v[120:121], v6 offset:2048
    ds_read_b64_tr_b16 v[122:123], v6 offset:2560
    s_waitcnt lgkmcnt(5)
    v_mfma_f32_32x32x16_bf16 v[32:47], v[104:107], v[96:99], v[32:47]
    ds_read_b128 v[112:115], v3
    ds_read_b128 v[116:119], v3 offset:4096
    s_waitcnt lgkmcnt(6)
    v_mfma_f32_32x32x16_bf16 v[48:63], v[104:107], v[100:103], v[48:63]
    ds_read_b64_tr_b16 v[124:125], v7 offset:2048
    ds_read_b64_tr_b16 v[126:127], v7 offset:2560
    s_waitcnt lgkmcnt(6)
    v_mfma_f32_32x32x16_bf16 v[64:79], v[108:111], v[96:99], v[64:79]
    v_mfma_f32_32x32x16_bf16 v[80:95], v[108:111], v[100:103], v[80:95]
    ds_read_b64_tr_b16 v[104:105], v6 offset:4096
    ds_read_b64_tr_b16 v[106:107], v6 offset:4608
    s_waitcnt lgkmcnt(5)
    v_mfma_f32_32x32x16_bf16 v[32:47], v[120:123], v[112:115], v[32:47]
    ds_read_b128 v[96:99], v4
    ds_read_b128 v[100:103], v4 offset:4096
    s_waitcnt lgkmcnt(6)
    v_mfma_f32_32x32x16_bf16 v[48:63], v[120:123], v[116:119], v[48:63]
    ds_read_b64_tr_b16 v[108:109], v7 offset:4096
    ds_read_b64_tr_b16 v[110:111], v7 offset:4608
    s_waitcnt lgkmcnt(6)
    v_mfma_f32_32x32x16_bf16 v[64:79], v[124:127], v[112:115], v[64:79]
    v_mfma_f32_32x32x16_bf16 v[80:95], v[124:127], v[116:119], v[80:95]
    ds_read_b64_tr_b16 v[120:121], v6 offset:6144
    ds_read_b64_tr_b16 v[122:123], v6 offset:6656
    s_waitcnt lgkmcnt(5)
    v_mfma_f32_32x32x16_bf16 v[32:47], v[104:107], v[96:99], v[32:47]
    ds_read_b128 v[112:115], v5
    ds_read_b128 v[116:119], v5 offset:4096
    s_waitcnt lgkmcnt(6)
    v_mfma_f32_32x32x16_bf16 v[48:63], v[104:107], v[100:103], v[48:63]
    ds_read_b64_tr_b16 v[124:125], v7 offset:6144
    ds_read_b64_tr_b16 v[126:127], v7 offset:6656
    s_waitcnt lgkmcnt(6)
    v_mfma_f32_32x32x16_bf16 v[64:79], v[108:111], v[96:99], v[64:79]
    v_mfma_f32_32x32x16_bf16 v[80:95], v[108:111], v[100:103], v[80:95]
    v_add_u32 v2, 0x8800, v2
    v_add_u32 v3, 0x8800, v3
    v_add_u32 v4, 0x8800, v4
    v_add_u32 v5, 0x8800, v5
    v_add_u32 v6, 0x8800, v6
    v_add_u32 v7, 0x8800, v7
    ds_read_b64_tr_b16 v[104:105], v6 offset:0
    ds_read_b64_tr_b16 v[106:107], v6 offset:512
    s_waitcnt lgkmcnt(5)
    v_mfma_f32_32x32x16_bf16 v[32:47], v[120:123], v[112:115], v[32:47]
    ds_read_b128 v[96:99], v2
    ds_read_b128 v[100:103], v2 offset:4096
    s_waitcnt lgkmcnt(6)
    v_mfma_f32_32x32x16_bf16 v[48:63], v[120:123], v[116:119], v[48:63]
    ds_read_b64_tr_b16 v[108:109], v7 offset:0
    ds_read_b64_tr_b16 v[110:111], v7 offset:512
    s_waitcnt lgkmcnt(6)
    v_mfma_f32_32x32x16_bf16 v[64:79], v[124:127], v[112:115], v[64:79]
    v_mfma_f32_32x32x16_bf16 v[80:95], v[124:127], v[116:119], v[80:95]
    ds_read_b64_tr_b16 v[120:121], v6 offset:2048
    ds_read_b64_tr_b16 v[122:123], v6 offset:2560
    s_waitcnt lgkmcnt(5)
    v_mfma_f32_32x32x16_bf16 v[32:47], v[104:107], v[96:99], v[32:47]
    ds_read_b128 v[112:115], v3
    ds_read_b128 v[116:119], v3 offset:4096
    s_waitcnt lgkmcnt(6)
    v_mfma_f32_32x32x16_bf16 v[48:63], v[104:107], v[100:103], v[48:63]
    ds_read_b64_tr_b16 v[124:125], v7 offset:2048
    ds_read_b64_tr_b16 v[126:127], v7 offset:2560
    s_waitcnt lgkmcnt(6)
    v_mfma_f32_32x32x16_bf16 v[64:79], v[108:111], v[96:99], v[64:79]
    v_mfma_f32_32x32x16_bf16 v[80:95], v[108:111], v[100:103], v[80:95]
    ds_read_b64_tr_b16 v[104:105], v6 offset:4096
    ds_read_b64_tr_b16 v[106:107], v6 offset:4608
    s_waitcnt lgkmcnt(5)
    v_mfma_f32_32x32x16_bf16 v[32:47], v[120:123], v[112:115], v[32:47]
    ds_read_b128 v[96:99], v4
    ds_read_b128 v[100:103], v4 offset:4096
    s_waitcnt lgkmcnt(6)
    v_mfma_f32_32x32x16_bf16 v[48:63], v[120:123], v[116:119], v[48:63]
    ds_read_b64_tr_b16 v[108:109], v7 offset:4096
    ds_read_b64_tr_b16 v[110:111], v7 offset:4608
    s_waitcnt lgkmcnt(6)
    v_mfma_f32_32x32x16_bf16 v[64:79], v[124:127], v[112:115], v[64:79]
    v_mfma_f32_32x32x16_bf16 v[80:95], v[124:127], v[116:119], v[80:95]
    ds_read_b64_tr_b16 v[120:121], v6 offset:6144
    ds_read_b64_tr_b16 v[122:123], v6 offset:6656
    s_waitcnt lgkmcnt(5)
    v_mfma_f32_32x32x16_bf16 v[32:47], v[104:107], v[96:99], v[32:47]
    ds_read_b128 v[112:115], v5
    ds_read_b128 v[116:119], v5 offset:4096
    s_waitcnt lgkmcnt(6)
    v_mfma_f32_32x32x16_bf16 v[48:63], v[104:107], v[100:103], v[48:63]
    ds_read_b64_tr_b16 v[124:125], v7 offset:6144
    ds_read_b64_tr_b16 v[126:127], v7 offset:6656
    s_waitcnt lgkmcnt(6)
    v_mfma_f32_32x32x16_bf16 v[64:79], v[108:111], v[96:99], v[64:79]
    v_mfma_f32_32x32x16_bf16 v[80:95], v[108:111], v[100:103], v[80:95]
    s_waitcnt lgkmcnt(3)
    v_mfma_f32_32x32x16_bf16 v[32:47], v[120:123], v[112:115], v[32:47]
    s_waitcnt lgkmcnt(2)
    v_mfma_f32_32x32x16_bf16 v[48:63], v[120:123], v[116:119], v[48:63]
    s_waitcnt lgkmcnt(0)
    v_mfma_f32_32x32x16_bf16 v[64:79], v[124:127], v[112:115], v[64:79]
    v_mfma_f32_32x32x16_bf16 v[80:95], v[124:127], v[116:119], v[80:95]
    v_lshrrev_b32 v9, 5, v1
    v_and_b32 v10, 31, v1
    s_lshl_b32 s6, s66, 8
    s_lshl_b32 s7, s67, 7
    s_add_u32 s6, s6, s7
    s_add_u32 s6, s6, 139264
    v_lshl_add_u32 v4, v9, 6, s6
    s_lshl_b32 s6, s68, 8
    s_lshl_b32 s7, s69, 7
    s_add_u32 s6, s6, s7
    s_add_u32 s6, s6, 139264
    v_lshl_add_u32 v5, v9, 6, s6
    v_lshlrev_b32 v6, 3, v10
    v_add_u32 v6, 0x22480, v6
    v_mul_u32_u24 v2, 144, v10
    v_lshl_add_u32 v2, v9, 5, v2
    v_mul_u32_u24 v3, 272, v10
    v_lshl_add_u32 v3, v9, 6, v3
    s_mul_i32 s6, s66, 11520
    s_lshl_b32 s7, s67, 6
    s_add_u32 s6, s6, s7
    v_add_u32 v2, s6, v2
    s_lshl_b32 s7, s69, 7
    s_add_u32 s7, s7, 25088
    v_add_u32 v3, s7, v3
    s_barrier
    ds_read_b64 v[160:161], v6 offset:0
    ds_read_b64 v[162:163], v6 offset:256
    ds_read_b128 v[128:131], v4 offset:0
    ds_read_b128 v[132:135], v4 offset:16
    ds_read_b128 v[136:139], v4 offset:32
    ds_read_b128 v[140:143], v4 offset:48
    ds_read_b128 v[144:147], v5 offset:0
    ds_read_b128 v[148:151], v5 offset:16
    ds_read_b128 v[152:155], v5 offset:32
    ds_read_b128 v[156:159], v5 offset:48
    s_waitcnt lgkmcnt(4)
    v_pk_fma_f32 v[32:33], v[128:129], v[160:161], v[32:33] op_sel_hi:[1,0,1]
    v_pk_fma_f32 v[34:35], v[130:131], v[160:161], v[34:35] op_sel_hi:[1,0,1]
    v_pk_fma_f32 v[36:37], v[132:133], v[160:161], v[36:37] op_sel_hi:[1,0,1]
    v_pk_fma_f32 v[38:39], v[134:135], v[160:161], v[38:39] op_sel_hi:[1,0,1]
    v_pk_fma_f32 v[40:41], v[136:137], v[160:161], v[40:41] op_sel_hi:[1,0,1]
    v_pk_fma_f32 v[42:43], v[138:139], v[160:161], v[42:43] op_sel_hi:[1,0,1]
    v_pk_fma_f32 v[44:45], v[140:141], v[160:161], v[44:45] op_sel_hi:[1,0,1]
    v_pk_fma_f32 v[46:47], v[142:143], v[160:161], v[46:47] op_sel_hi:[1,0,1]
    v_pk_mul_f32 v[32:33], v[32:33], v[160:161] op_sel:[0,1] op_sel_hi:[1,1]
    v_pk_mul_f32 v[34:35], v[34:35], v[160:161] op_sel:[0,1] op_sel_hi:[1,1]
    v_pk_mul_f32 v[36:37], v[36:37], v[160:161] op_sel:[0,1] op_sel_hi:[1,1]
    v_pk_mul_f32 v[38:39], v[38:39], v[160:161] op_sel:[0,1] op_sel_hi:[1,1]
    v_pk_mul_f32 v[40:41], v[40:41], v[160:161] op_sel:[0,1] op_sel_hi:[1,1]
    v_pk_mul_f32 v[42:43], v[42:43], v[160:161] op_sel:[0,1] op_sel_hi:[1,1]
    v_pk_mul_f32 v[44:45], v[44:45], v[160:161] op_sel:[0,1] op_sel_hi:[1,1]
    v_pk_mul_f32 v[46:47], v[46:47], v[160:161] op_sel:[0,1] op_sel_hi:[1,1]
    v_cvt_pk_bf16_f32 v168, v32, v33
    v_cvt_pk_bf16_f32 v169, v34, v35
    v_cvt_pk_bf16_f32 v170, v36, v37
    v_cvt_pk_bf16_f32 v171, v38, v39
    v_cvt_pk_bf16_f32 v172, v40, v41
    v_cvt_pk_bf16_f32 v173, v42, v43
    v_cvt_pk_bf16_f32 v174, v44, v45
    v_cvt_pk_bf16_f32 v175, v46, v47
    ds_write_b128 v2, v[168:171] offset:0
    ds_write_b128 v2, v[172:175] offset:16
    v_pk_fma_f32 v[48:49], v[128:129], v[162:163], v[48:49] op_sel_hi:[1,0,1]
    v_pk_fma_f32 v[50:51], v[130:131], v[162:163], v[50:51] op_sel_hi:[1,0,1]
    v_pk_fma_f32 v[52:53], v[132:133], v[162:163], v[52:53] op_sel_hi:[1,0,1]
    v_pk_fma_f32 v[54:55], v[134:135], v[162:163], v[54:55] op_sel_hi:[1,0,1]
    v_pk_fma_f32 v[56:57], v[136:137], v[162:163], v[56:57] op_sel_hi:[1,0,1]
    v_pk_fma_f32 v[58:59], v[138:139], v[162:163], v[58:59] op_sel_hi:[1,0,1]
    v_pk_fma_f32 v[60:61], v[140:141], v[162:163], v[60:61] op_sel_hi:[1,0,1]
    v_pk_fma_f32 v[62:63], v[142:143], v[162:163], v[62:63] op_sel_hi:[1,0,1]
    v_pk_mul_f32 v[48:49], v[48:49], v[162:163] op_sel:[0,1] op_sel_hi:[1,1]
    v_pk_mul_f32 v[50:51], v[50:51], v[162:163] op_sel:[0,1] op_sel_hi:[1,1]
    v_pk_mul_f32 v[52:53], v[52:53], v[162:163] op_sel:[0,1] op_sel_hi:[1,1]
    v_pk_mul_f32 v[54:55], v[54:55], v[162:163] op_sel:[0,1] op_sel_hi:[1,1]
    v_pk_mul_f32 v[56:57], v[56:57], v[162:163] op_sel:[0,1] op_sel_hi:[1,1]
    v_pk_mul_f32 v[58:59], v[58:59], v[162:163] op_sel:[0,1] op_sel_hi:[1,1]
    v_pk_mul_f32 v[60:61], v[60:61], v[162:163] op_sel:[0,1] op_sel_hi:[1,1]
    v_pk_mul_f32 v[62:63], v[62:63], v[162:163] op_sel:[0,1] op_sel_hi:[1,1]
    v_cvt_pk_bf16_f32 v176, v48, v49
    v_cvt_pk_bf16_f32 v177, v50, v51
    v_cvt_pk_bf16_f32 v178, v52, v53
    v_cvt_pk_bf16_f32 v179, v54, v55
    v_cvt_pk_bf16_f32 v180, v56, v57
    v_cvt_pk_bf16_f32 v181, v58, v59
    v_cvt_pk_bf16_f32 v182, v60, v61
    v_cvt_pk_bf16_f32 v183, v62, v63
    ds_write_b128 v2, v[176:179] offset:4608
    ds_write_b128 v2, v[180:183] offset:4624
    s_waitcnt lgkmcnt(0)
    v_pk_fma_f32 v[64:65], v[144:145], v[160:161], v[64:65] op_sel_hi:[1,0,1]
    v_pk_fma_f32 v[66:67], v[146:147], v[160:161], v[66:67] op_sel_hi:[1,0,1]
    v_pk_fma_f32 v[68:69], v[148:149], v[160:161], v[68:69] op_sel_hi:[1,0,1]
    v_pk_fma_f32 v[70:71], v[150:151], v[160:161], v[70:71] op_sel_hi:[1,0,1]
    v_pk_fma_f32 v[72:73], v[152:153], v[160:161], v[72:73] op_sel_hi:[1,0,1]
    v_pk_fma_f32 v[74:75], v[154:155], v[160:161], v[74:75] op_sel_hi:[1,0,1]
    v_pk_fma_f32 v[76:77], v[156:157], v[160:161], v[76:77] op_sel_hi:[1,0,1]
    v_pk_fma_f32 v[78:79], v[158:159], v[160:161], v[78:79] op_sel_hi:[1,0,1]
    v_pk_mul_f32 v[64:65], v[64:65], v[160:161] op_sel:[0,1] op_sel_hi:[1,1]
    v_pk_mul_f32 v[66:67], v[66:67], v[160:161] op_sel:[0,1] op_sel_hi:[1,1]
    v_pk_mul_f32 v[68:69], v[68:69], v[160:161] op_sel:[0,1] op_sel_hi:[1,1]
    v_pk_mul_f32 v[70:71], v[70:71], v[160:161] op_sel:[0,1] op_sel_hi:[1,1]
    v_pk_mul_f32 v[72:73], v[72:73], v[160:161] op_sel:[0,1] op_sel_hi:[1,1]
    v_pk_mul_f32 v[74:75], v[74:75], v[160:161] op_sel:[0,1] op_sel_hi:[1,1]
    v_pk_mul_f32 v[76:77], v[76:77], v[160:161] op_sel:[0,1] op_sel_hi:[1,1]
    v_pk_mul_f32 v[78:79], v[78:79], v[160:161] op_sel:[0,1] op_sel_hi:[1,1]
    v_pk_fma_f32 v[80:81], v[144:145], v[162:163], v[80:81] op_sel_hi:[1,0,1]
    v_pk_fma_f32 v[82:83], v[146:147], v[162:163], v[82:83] op_sel_hi:[1,0,1]
    v_pk_fma_f32 v[84:85], v[148:149], v[162:163], v[84:85] op_sel_hi:[1,0,1]
    v_pk_fma_f32 v[86:87], v[150:151], v[162:163], v[86:87] op_sel_hi:[1,0,1]
    v_pk_fma_f32 v[88:89], v[152:153], v[162:163], v[88:89] op_sel_hi:[1,0,1]
    v_pk_fma_f32 v[90:91], v[154:155], v[162:163], v[90:91] op_sel_hi:[1,0,1]
    v_pk_fma_f32 v[92:93], v[156:157], v[162:163], v[92:93] op_sel_hi:[1,0,1]
    v_pk_fma_f32 v[94:95], v[158:159], v[162:163], v[94:95] op_sel_hi:[1,0,1]
    v_pk_mul_f32 v[80:81], v[80:81], v[162:163] op_sel:[0,1] op_sel_hi:[1,1]
    v_pk_mul_f32 v[82:83], v[82:83], v[162:163] op_sel:[0,1] op_sel_hi:[1,1]
    v_pk_mul_f32 v[84:85], v[84:85], v[162:163] op_sel:[0,1] op_sel_hi:[1,1]
    v_pk_mul_f32 v[86:87], v[86:87], v[162:163] op_sel:[0,1] op_sel_hi:[1,1]
    v_pk_mul_f32 v[88:89], v[88:89], v[162:163] op_sel:[0,1] op_sel_hi:[1,1]
    v_pk_mul_f32 v[90:91], v[90:91], v[162:163] op_sel:[0,1] op_sel_hi:[1,1]
    v_pk_mul_f32 v[92:93], v[92:93], v[162:163] op_sel:[0,1] op_sel_hi:[1,1]
    v_pk_mul_f32 v[94:95], v[94:95], v[162:163] op_sel:[0,1] op_sel_hi:[1,1]
    s_cmp_lg_u32 s3, 0
    s_cbranch_scc1 p1v_15
    v_cvt_pk_bf16_f32 v184, v64, v65
    v_cvt_pk_bf16_f32 v185, v66, v67
    v_cvt_pk_bf16_f32 v186, v68, v69
    v_cvt_pk_bf16_f32 v187, v70, v71
    v_cvt_pk_bf16_f32 v188, v72, v73
    v_cvt_pk_bf16_f32 v189, v74, v75
    v_cvt_pk_bf16_f32 v190, v76, v77
    v_cvt_pk_bf16_f32 v191, v78, v79
    ds_write_b128 v2, v[184:187] offset:64
    ds_write_b128 v2, v[188:191] offset:80
    v_cvt_pk_bf16_f32 v192, v80, v81
    v_cvt_pk_bf16_f32 v193, v82, v83
    v_cvt_pk_bf16_f32 v194, v84, v85
    v_cvt_pk_bf16_f32 v195, v86, v87
    v_cvt_pk_bf16_f32 v196, v88, v89
    v_cvt_pk_bf16_f32 v197, v90, v91
    v_cvt_pk_bf16_f32 v198, v92, v93
    v_cvt_pk_bf16_f32 v199, v94, v95
    ds_write_b128 v2, v[192:195] offset:4672
    ds_write_b128 v2, v[196:199] offset:4688
    s_branch p1att_4
p1v_15:
    ds_write_b128 v3, v[64:67] offset:0
    ds_write_b128 v3, v[68:71] offset:16
    ds_write_b128 v3, v[72:75] offset:32
    ds_write_b128 v3, v[76:79] offset:48
    ds_write_b128 v3, v[80:83] offset:8704
    ds_write_b128 v3, v[84:87] offset:8720
    ds_write_b128 v3, v[88:91] offset:8736
    ds_write_b128 v3, v[92:95] offset:8752
    s_branch p1att_4
p1h_2:
    s_setprio 1
    v_and_b32 v9, 15, v1
    v_lshrrev_b32 v10, 4, v1
    v_bfe_u32 v11, v9, 1, 3
    v_xor_b32 v10, v10, v11
    v_lshlrev_b32 v10, 4, v10
    v_lshl_add_u32 v2, v9, 7, v10
    v_xor_b32 v3, 64, v2
    v_lshrrev_b32 v9, 4, v1
    v_bfe_u32 v10, v1, 2, 2
    v_lshl_add_u32 v4, v9, 3, v10
    v_lshlrev_b32 v4, 7, v4
    v_and_b32 v9, 1, v9
    v_lshlrev_b32 v9, 1, v9
    v_lshrrev_b32 v10, 1, v10
    v_lshl_or_b32 v9, v10, 2, v9
    v_bfe_u32 v10, v1, 1, 1
    v_or_b32 v9, v9, v10
    v_lshl_add_u32 v4, v9, 4, v4
    v_and_b32 v9, 1, v1
    v_lshl_add_u32 v4, v9, 3, v4
    v_add_u32 v4, 10240, v4
    v_xor_b32 v5, 32, v4
    v_xor_b32 v6, 64, v4
    v_xor_b32 v7, 96, v4
    v_and_b32 v9, 15, v1
    v_cmp_eq_u32 vcc, 0, v9
    v_mov_b32 v12, s15
    s_cmp_eq_u32 s100, 0
    s_cbranch_scc1 w0_16
    s_waitcnt vmcnt(2)
    s_branch w1_17
w0_16:
    s_waitcnt vmcnt(8)
w1_17:
    s_barrier
    ds_read_b128 v[80:83], v2
    ds_read_b64_tr_b16 v[96:97], v4 offset:0
    ds_read_b64_tr_b16 v[98:99], v4 offset:512
    ds_read_b64_tr_b16 v[100:101], v5 offset:0
    ds_read_b64_tr_b16 v[102:103], v5 offset:512
    ds_read_b64_tr_b16 v[104:105], v6 offset:0
    ds_read_b64_tr_b16 v[106:107], v6 offset:512
    ds_read_b64_tr_b16 v[108:109], v7 offset:0
    ds_read_b64_tr_b16 v[110:111], v7 offset:512
    s_waitcnt lgkmcnt(8)
    v_cndmask_b32 v80, v80, v12, vcc
    v_cndmask_b32 v81, v81, v12, vcc
    v_cndmask_b32 v82, v82, v12, vcc
    v_cndmask_b32 v83, v83, v12, vcc
    s_nop 1
    ds_read_b64_tr_b16 v[112:113], v4 offset:8192
    ds_read_b64_tr_b16 v[114:115], v4 offset:8704
    s_waitcnt lgkmcnt(8)
    v_mfma_f32_16x16x32_bf16 v[32:35], v[96:99], v[80:83], 0
    ds_read_b64_tr_b16 v[116:117], v5 offset:8192
    ds_read_b64_tr_b16 v[118:119], v5 offset:8704
    s_waitcnt lgkmcnt(8)
    v_mfma_f32_16x16x32_bf16 v[36:39], v[100:103], v[80:83], 0
    ds_read_b64_tr_b16 v[120:121], v6 offset:8192
    ds_read_b64_tr_b16 v[122:123], v6 offset:8704
    s_waitcnt lgkmcnt(8)
    v_mfma_f32_16x16x32_bf16 v[40:43], v[104:107], v[80:83], 0
    ds_read_b64_tr_b16 v[124:125], v7 offset:8192
    ds_read_b64_tr_b16 v[126:127], v7 offset:8704
    s_waitcnt lgkmcnt(8)
    v_mfma_f32_16x16x32_bf16 v[44:47], v[108:111], v[80:83], 0
    ds_read_b64_tr_b16 v[96:97], v4 offset:16384
    ds_read_b64_tr_b16 v[98:99], v4 offset:16896
    s_waitcnt lgkmcnt(8)
    v_mfma_f32_16x16x32_bf16 v[48:51], v[112:115], v[80:83], 0
    ds_read_b64_tr_b16 v[100:101], v5 offset:16384
    ds_read_b64_tr_b16 v[102:103], v5 offset:16896
    s_waitcnt lgkmcnt(8)
    v_mfma_f32_16x16x32_bf16 v[52:55], v[116:119], v[80:83], 0
    ds_read_b64_tr_b16 v[104:105], v6 offset:16384
    ds_read_b64_tr_b16 v[106:107], v6 offset:16896
    s_waitcnt lgkmcnt(8)
    v_mfma_f32_16x16x32_bf16 v[56:59], v[120:123], v[80:83], 0
    ds_read_b64_tr_b16 v[108:109], v7 offset:16384
    ds_read_b64_tr_b16 v[110:111], v7 offset:16896
    s_waitcnt lgkmcnt(8)
    v_mfma_f32_16x16x32_bf16 v[60:63], v[124:127], v[80:83], 0
    ds_read_b128 v[84:87], v3
    ds_read_b64_tr_b16 v[112:113], v4 offset:4096
    ds_read_b64_tr_b16 v[114:115], v4 offset:4608
    s_waitcnt lgkmcnt(9)
    v_mfma_f32_16x16x32_bf16 v[64:67], v[96:99], v[80:83], 0
    ds_read_b64_tr_b16 v[116:117], v5 offset:4096
    ds_read_b64_tr_b16 v[118:119], v5 offset:4608
    s_waitcnt lgkmcnt(9)
    v_mfma_f32_16x16x32_bf16 v[68:71], v[100:103], v[80:83], 0
    ds_read_b64_tr_b16 v[120:121], v6 offset:4096
    ds_read_b64_tr_b16 v[122:123], v6 offset:4608
    s_waitcnt lgkmcnt(9)
    v_mfma_f32_16x16x32_bf16 v[72:75], v[104:107], v[80:83], 0
    ds_read_b64_tr_b16 v[124:125], v7 offset:4096
    ds_read_b64_tr_b16 v[126:127], v7 offset:4608
    s_waitcnt lgkmcnt(9)
    v_mfma_f32_16x16x32_bf16 v[76:79], v[108:111], v[80:83], 0
    s_waitcnt lgkmcnt(8)
    v_cndmask_b32 v84, v84, v12, vcc
    v_cndmask_b32 v85, v85, v12, vcc
    v_cndmask_b32 v86, v86, v12, vcc
    v_cndmask_b32 v87, v87, v12, vcc
    s_nop 1
    ds_read_b64_tr_b16 v[96:97], v4 offset:12288
    ds_read_b64_tr_b16 v[98:99], v4 offset:12800
    s_waitcnt lgkmcnt(8)
    v_mfma_f32_16x16x32_bf16 v[32:35], v[112:115], v[84:87], v[32:35]
    ds_read_b64_tr_b16 v[100:101], v5 offset:12288
    ds_read_b64_tr_b16 v[102:103], v5 offset:12800
    s_waitcnt lgkmcnt(8)
    v_mfma_f32_16x16x32_bf16 v[36:39], v[116:119], v[84:87], v[36:39]
    ds_read_b64_tr_b16 v[104:105], v6 offset:12288
    ds_read_b64_tr_b16 v[106:107], v6 offset:12800
    s_waitcnt lgkmcnt(8)
    v_mfma_f32_16x16x32_bf16 v[40:43], v[120:123], v[84:87], v[40:43]
    ds_read_b64_tr_b16 v[108:109], v7 offset:12288
    ds_read_b64_tr_b16 v[110:111], v7 offset:12800
    s_waitcnt lgkmcnt(8)
    v_mfma_f32_16x16x32_bf16 v[44:47], v[124:127], v[84:87], v[44:47]
    ds_read_b64_tr_b16 v[112:113], v4 offset:20480
    ds_read_b64_tr_b16 v[114:115], v4 offset:20992
    s_waitcnt lgkmcnt(8)
    v_mfma_f32_16x16x32_bf16 v[48:51], v[96:99], v[84:87], v[48:51]
    ds_read_b64_tr_b16 v[116:117], v5 offset:20480
    ds_read_b64_tr_b16 v[118:119], v5 offset:20992
    s_waitcnt lgkmcnt(8)
    v_mfma_f32_16x16x32_bf16 v[52:55], v[100:103], v[84:87], v[52:55]
    ds_read_b64_tr_b16 v[120:121], v6 offset:20480
    ds_read_b64_tr_b16 v[122:123], v6 offset:20992
    s_waitcnt lgkmcnt(8)
    v_mfma_f32_16x16x32_bf16 v[56:59], v[104:107], v[84:87], v[56:59]
    ds_read_b64_tr_b16 v[124:125], v7 offset:20480
    ds_read_b64_tr_b16 v[126:127], v7 offset:20992
    s_waitcnt lgkmcnt(8)
    v_mfma_f32_16x16x32_bf16 v[60:63], v[108:111], v[84:87], v[60:63]
    s_cmp_eq_u32 s100, 0
    s_cbranch_scc1 w0_18
    s_waitcnt vmcnt(1)
    s_branch w1_19
w0_18:
    s_waitcnt vmcnt(4)
w1_19:
    s_waitcnt lgkmcnt(0)
    v_add_u32 v2, 0x8800, v2
    v_add_u32 v3, 0x8800, v3
    v_add_u32 v4, 0x8800, v4
    v_add_u32 v5, 0x8800, v5
    v_add_u32 v6, 0x8800, v6
    v_add_u32 v7, 0x8800, v7
    s_barrier
    ds_read_b128 v[80:83], v2
    ds_read_b64_tr_b16 v[96:97], v4 offset:0
    ds_read_b64_tr_b16 v[98:99], v4 offset:512
    v_mfma_f32_16x16x32_bf16 v[64:67], v[112:115], v[84:87], v[64:67]
    ds_read_b64_tr_b16 v[100:101], v5 offset:0
    ds_read_b64_tr_b16 v[102:103], v5 offset:512
    v_mfma_f32_16x16x32_bf16 v[68:71], v[116:119], v[84:87], v[68:71]
    ds_read_b64_tr_b16 v[104:105], v6 offset:0
    ds_read_b64_tr_b16 v[106:107], v6 offset:512
    v_mfma_f32_16x16x32_bf16 v[72:75], v[120:123], v[84:87], v[72:75]
    ds_read_b64_tr_b16 v[108:109], v7 offset:0
    ds_read_b64_tr_b16 v[110:111], v7 offset:512
    v_mfma_f32_16x16x32_bf16 v[76:79], v[124:127], v[84:87], v[76:79]
    s_waitcnt lgkmcnt(8)
    v_cndmask_b32 v80, v80, v12, vcc
    v_cndmask_b32 v81, v81, v12, vcc
    v_cndmask_b32 v82, v82, v12, vcc
    v_cndmask_b32 v83, v83, v12, vcc
    s_nop 1
    ds_read_b64_tr_b16 v[112:113], v4 offset:8192
    ds_read_b64_tr_b16 v[114:115], v4 offset:8704
    s_waitcnt lgkmcnt(8)
    v_mfma_f32_16x16x32_bf16 v[32:35], v[96:99], v[80:83], v[32:35]
    ds_read_b64_tr_b16 v[116:117], v5 offset:8192
    ds_read_b64_tr_b16 v[118:119], v5 offset:8704
    s_waitcnt lgkmcnt(8)
    v_mfma_f32_16x16x32_bf16 v[36:39], v[100:103], v[80:83], v[36:39]
    ds_read_b64_tr_b16 v[120:121], v6 offset:8192
    ds_read_b64_tr_b16 v[122:123], v6 offset:8704
    s_waitcnt lgkmcnt(8)
    v_mfma_f32_16x16x32_bf16 v[40:43], v[104:107], v[80:83], v[40:43]
    ds_read_b64_tr_b16 v[124:125], v7 offset:8192
    ds_read_b64_tr_b16 v[126:127], v7 offset:8704
    s_waitcnt lgkmcnt(8)
    v_mfma_f32_16x16x32_bf16 v[44:47], v[108:111], v[80:83], v[44:47]
    ds_read_b64_tr_b16 v[96:97], v4 offset:16384
    ds_read_b64_tr_b16 v[98:99], v4 offset:16896
    s_waitcnt lgkmcnt(8)
    v_mfma_f32_16x16x32_bf16 v[48:51], v[112:115], v[80:83], v[48:51]
    ds_read_b64_tr_b16 v[100:101], v5 offset:16384
    ds_read_b64_tr_b16 v[102:103], v5 offset:16896
    s_waitcnt lgkmcnt(8)
    v_mfma_f32_16x16x32_bf16 v[52:55], v[116:119], v[80:83], v[52:55]
    ds_read_b64_tr_b16 v[104:105], v6 offset:16384
    ds_read_b64_tr_b16 v[106:107], v6 offset:16896
    s_waitcnt lgkmcnt(8)
    v_mfma_f32_16x16x32_bf16 v[56:59], v[120:123], v[80:83], v[56:59]
    ds_read_b64_tr_b16 v[108:109], v7 offset:16384
    ds_read_b64_tr_b16 v[110:111], v7 offset:16896
    s_waitcnt lgkmcnt(8)
    v_mfma_f32_16x16x32_bf16 v[60:63], v[124:127], v[80:83], v[60:63]
    ds_read_b128 v[84:87], v3
    ds_read_b64_tr_b16 v[112:113], v4 offset:4096
    ds_read_b64_tr_b16 v[114:115], v4 offset:4608
    s_waitcnt lgkmcnt(9)
    v_mfma_f32_16x16x32_bf16 v[64:67], v[96:99], v[80:83], v[64:67]
    ds_read_b64_tr_b16 v[116:117], v5 offset:4096
    ds_read_b64_tr_b16 v[118:119], v5 offset:4608
    s_waitcnt lgkmcnt(9)
    v_mfma_f32_16x16x32_bf16 v[68:71], v[100:103], v[80:83], v[68:71]
    ds_read_b64_tr_b16 v[120:121], v6 offset:4096
    ds_read_b64_tr_b16 v[122:123], v6 offset:4608
    s_waitcnt lgkmcnt(9)
    v_mfma_f32_16x16x32_bf16 v[72:75], v[104:107], v[80:83], v[72:75]
    ds_read_b64_tr_b16 v[124:125], v7 offset:4096
    ds_read_b64_tr_b16 v[126:127], v7 offset:4608
    s_waitcnt lgkmcnt(9)
    v_mfma_f32_16x16x32_bf16 v[76:79], v[108:111], v[80:83], v[76:79]
    s_waitcnt lgkmcnt(8)
    v_cndmask_b32 v84, v84, v12, vcc
    v_cndmask_b32 v85, v85, v12, vcc
    v_cndmask_b32 v86, v86, v12, vcc
    v_cndmask_b32 v87, v87, v12, vcc
    s_nop 1
    ds_read_b64_tr_b16 v[96:97], v4 offset:12288
    ds_read_b64_tr_b16 v[98:99], v4 offset:12800
    s_waitcnt lgkmcnt(8)
    v_mfma_f32_16x16x32_bf16 v[32:35], v[112:115], v[84:87], v[32:35]
    ds_read_b64_tr_b16 v[100:101], v5 offset:12288
    ds_read_b64_tr_b16 v[102:103], v5 offset:12800
    s_waitcnt lgkmcnt(8)
    v_mfma_f32_16x16x32_bf16 v[36:39], v[116:119], v[84:87], v[36:39]
    ds_read_b64_tr_b16 v[104:105], v6 offset:12288
    ds_read_b64_tr_b16 v[106:107], v6 offset:12800
    s_waitcnt lgkmcnt(8)
    v_mfma_f32_16x16x32_bf16 v[40:43], v[120:123], v[84:87], v[40:43]
    ds_read_b64_tr_b16 v[108:109], v7 offset:12288
    ds_read_b64_tr_b16 v[110:111], v7 offset:12800
    s_waitcnt lgkmcnt(8)
    v_mfma_f32_16x16x32_bf16 v[44:47], v[124:127], v[84:87], v[44:47]
    ds_read_b64_tr_b16 v[112:113], v4 offset:20480
    ds_read_b64_tr_b16 v[114:115], v4 offset:20992
    s_waitcnt lgkmcnt(8)
    v_mfma_f32_16x16x32_bf16 v[48:51], v[96:99], v[84:87], v[48:51]
    ds_read_b64_tr_b16 v[116:117], v5 offset:20480
    ds_read_b64_tr_b16 v[118:119], v5 offset:20992
    s_waitcnt lgkmcnt(8)
    v_mfma_f32_16x16x32_bf16 v[52:55], v[100:103], v[84:87], v[52:55]
    ds_read_b64_tr_b16 v[120:121], v6 offset:20480
    ds_read_b64_tr_b16 v[122:123], v6 offset:20992
    s_waitcnt lgkmcnt(8)
    v_mfma_f32_16x16x32_bf16 v[56:59], v[104:107], v[84:87], v[56:59]
    ds_read_b64_tr_b16 v[124:125], v7 offset:20480
    ds_read_b64_tr_b16 v[126:127], v7 offset:20992
    s_waitcnt lgkmcnt(8)
    v_mfma_f32_16x16x32_bf16 v[60:63], v[108:111], v[84:87], v[60:63]
    s_waitcnt vmcnt(0)
    s_waitcnt lgkmcnt(0)
    v_add_u32 v2, 0x8800, v2
    v_add_u32 v3, 0x8800, v3
    v_add_u32 v4, 0x8800, v4
    v_add_u32 v5, 0x8800, v5
    v_add_u32 v6, 0x8800, v6
    v_add_u32 v7, 0x8800, v7
    s_barrier
    s_cmp_lg_u32 s100, 0
    s_cbranch_scc1 ifl_20
    s_getreg_b32 s6, hwreg(HW_REG_XCC_ID, 0, 3)
    s_mul_i32 s6, s6, 6
    s_lshl_b64 s[70:71], 1, s6
    s_add_u32 s71, s71, 0x1000000
    s_lshl_b32 s7, s4, 4
    v_mov_b32 v212, s7
    v_mov_b32 v214, s70
    v_mov_b32 v215, s71
    s_mov_b64 exec, 1
    buffer_atomic_add_x2 v[214:215], v212, s[24:27], 0 offen
    s_cmp_lg_u32 s2, 0
    s_cbranch_scc1 notag_21
    v_mov_b32 v212, 0x3000
    buffer_load_dword v213, v212, s[96:99], 0 offen sc1
    s_waitcnt vmcnt(0)
    v_add_u32 v213, 0x9e3779b9, v213
    v_max_u32 v213, 1, v213
    buffer_store_dword v213, v212, s[96:99], 0 offen sc1
    v_mov_b32 v212, 0x80
    buffer_store_dword v213, v212, s[24:27], 0 offen sc1
notag_21:
    s_mov_b64 exec, -1
    s_nop 3
ifl_20:
    ds_read_b128 v[80:83], v2
    ds_read_b64_tr_b16 v[96:97], v4 offset:0
    ds_read_b64_tr_b16 v[98:99], v4 offset:512
    v_mfma_f32_16x16x32_bf16 v[64:67], v[112:115], v[84:87], v[64:67]
    ds_read_b64_tr_b16 v[100:101], v5 offset:0
    ds_read_b64_tr_b16 v[102:103], v5 offset:512
    v_mfma_f32_16x16x32_bf16 v[68:71], v[116:119], v[84:87], v[68:71]
    ds_read_b64_tr_b16 v[104:105], v6 offset:0
    ds_read_b64_tr_b16 v[106:107], v6 offset:512
    v_mfma_f32_16x16x32_bf16 v[72:75], v[120:123], v[84:87], v[72:75]
    ds_read_b64_tr_b16 v[108:109], v7 offset:0
    ds_read_b64_tr_b16 v[110:111], v7 offset:512
    v_mfma_f32_16x16x32_bf16 v[76:79], v[124:127], v[84:87], v[76:79]
    s_waitcnt lgkmcnt(8)
    v_cndmask_b32 v80, v80, v12, vcc
    v_cndmask_b32 v81, v81, v12, vcc
    v_cndmask_b32 v82, v82, v12, vcc
    v_cndmask_b32 v83, v83, v12, vcc
    s_nop 1
    ds_read_b64_tr_b16 v[112:113], v4 offset:8192
    ds_read_b64_tr_b16 v[114:115], v4 offset:8704
    s_waitcnt lgkmcnt(8)
    v_mfma_f32_16x16x32_bf16 v[32:35], v[96:99], v[80:83], v[32:35]
    ds_read_b64_tr_b16 v[116:117], v5 offset:8192
    ds_read_b64_tr_b16 v[118:119], v5 offset:8704
    s_waitcnt lgkmcnt(8)
    v_mfma_f32_16x16x32_bf16 v[36:39], v[100:103], v[80:83], v[36:39]
    ds_read_b64_tr_b16 v[120:121], v6 offset:8192
    ds_read_b64_tr_b16 v[122:123], v6 offset:8704
    s_waitcnt lgkmcnt(8)
    v_mfma_f32_16x16x32_bf16 v[40:43], v[104:107], v[80:83], v[40:43]
    ds_read_b64_tr_b16 v[124:125], v7 offset:8192
    ds_read_b64_tr_b16 v[126:127], v7 offset:8704
    s_waitcnt lgkmcnt(8)
    v_mfma_f32_16x16x32_bf16 v[44:47], v[108:111], v[80:83], v[44:47]
    ds_read_b64_tr_b16 v[96:97], v4 offset:16384
    ds_read_b64_tr_b16 v[98:99], v4 offset:16896
    s_waitcnt lgkmcnt(8)
    v_mfma_f32_16x16x32_bf16 v[48:51], v[112:115], v[80:83], v[48:51]
    ds_read_b64_tr_b16 v[100:101], v5 offset:16384
    ds_read_b64_tr_b16 v[102:103], v5 offset:16896
    s_waitcnt lgkmcnt(8)
    v_mfma_f32_16x16x32_bf16 v[52:55], v[116:119], v[80:83], v[52:55]
    ds_read_b64_tr_b16 v[104:105], v6 offset:16384
    ds_read_b64_tr_b16 v[106:107], v6 offset:16896
    s_waitcnt lgkmcnt(8)
    v_mfma_f32_16x16x32_bf16 v[56:59], v[120:123], v[80:83], v[56:59]
    ds_read_b64_tr_b16 v[108:109], v7 offset:16384
    ds_read_b64_tr_b16 v[110:111], v7 offset:16896
    s_waitcnt lgkmcnt(8)
    v_mfma_f32_16x16x32_bf16 v[60:63], v[124:127], v[80:83], v[60:63]
    ds_read_b128 v[84:87], v3
    ds_read_b64_tr_b16 v[112:113], v4 offset:4096
    ds_read_b64_tr_b16 v[114:115], v4 offset:4608
    s_waitcnt lgkmcnt(9)
    v_mfma_f32_16x16x32_bf16 v[64:67], v[96:99], v[80:83], v[64:67]
    ds_read_b64_tr_b16 v[116:117], v5 offset:4096
    ds_read_b64_tr_b16 v[118:119], v5 offset:4608
    s_waitcnt lgkmcnt(9)
    v_mfma_f32_16x16x32_bf16 v[68:71], v[100:103], v[80:83], v[68:71]
    ds_read_b64_tr_b16 v[120:121], v6 offset:4096
    ds_read_b64_tr_b16 v[122:123], v6 offset:4608
    s_waitcnt lgkmcnt(9)
    v_mfma_f32_16x16x32_bf16 v[72:75], v[104:107], v[80:83], v[72:75]
    ds_read_b64_tr_b16 v[124:125], v7 offset:4096
    ds_read_b64_tr_b16 v[126:127], v7 offset:4608
    s_waitcnt lgkmcnt(9)
    v_mfma_f32_16x16x32_bf16 v[76:79], v[108:111], v[80:83], v[76:79]
    s_waitcnt lgkmcnt(8)
    v_cndmask_b32 v84, v84, v12, vcc
    v_cndmask_b32 v85, v85, v12, vcc
    v_cndmask_b32 v86, v86, v12, vcc
    v_cndmask_b32 v87, v87, v12, vcc
    s_nop 1
    ds_read_b64_tr_b16 v[96:97], v4 offset:12288
    ds_read_b64_tr_b16 v[98:99], v4 offset:12800
    s_waitcnt lgkmcnt(8)
    v_mfma_f32_16x16x32_bf16 v[32:35], v[112:115], v[84:87], v[32:35]
    ds_read_b64_tr_b16 v[100:101], v5 offset:12288
    ds_read_b64_tr_b16 v[102:103], v5 offset:12800
    s_waitcnt lgkmcnt(8)
    v_mfma_f32_16x16x32_bf16 v[36:39], v[116:119], v[84:87], v[36:39]
    ds_read_b64_tr_b16 v[104:105], v6 offset:12288
    ds_read_b64_tr_b16 v[106:107], v6 offset:12800
    s_waitcnt lgkmcnt(8)
    v_mfma_f32_16x16x32_bf16 v[40:43], v[120:123], v[84:87], v[40:43]
    ds_read_b64_tr_b16 v[108:109], v7 offset:12288
    ds_read_b64_tr_b16 v[110:111], v7 offset:12800
    s_waitcnt lgkmcnt(8)
    v_mfma_f32_16x16x32_bf16 v[44:47], v[124:127], v[84:87], v[44:47]
    ds_read_b64_tr_b16 v[112:113], v4 offset:20480
    ds_read_b64_tr_b16 v[114:115], v4 offset:20992
    s_waitcnt lgkmcnt(8)
    v_mfma_f32_16x16x32_bf16 v[48:51], v[96:99], v[84:87], v[48:51]
    ds_read_b64_tr_b16 v[116:117], v5 offset:20480
    ds_read_b64_tr_b16 v[118:119], v5 offset:20992
    s_waitcnt lgkmcnt(8)
    v_mfma_f32_16x16x32_bf16 v[52:55], v[100:103], v[84:87], v[52:55]
    ds_read_b64_tr_b16 v[120:121], v6 offset:20480
    ds_read_b64_tr_b16 v[122:123], v6 offset:20992
    s_waitcnt lgkmcnt(8)
    v_mfma_f32_16x16x32_bf16 v[56:59], v[104:107], v[84:87], v[56:59]
    ds_read_b64_tr_b16 v[124:125], v7 offset:20480
    ds_read_b64_tr_b16 v[126:127], v7 offset:20992
    s_waitcnt lgkmcnt(8)
    v_mfma_f32_16x16x32_bf16 v[60:63], v[108:111], v[84:87], v[60:63]
    s_waitcnt lgkmcnt(0)
    v_add_u32 v2, 0x8800, v2
    v_add_u32 v3, 0x8800, v3
    v_add_u32 v4, 0x8800, v4
    v_add_u32 v5, 0x8800, v5
    v_add_u32 v6, 0x8800, v6
    v_add_u32 v7, 0x8800, v7
    s_barrier
    ds_read_b128 v[80:83], v2
    ds_read_b64_tr_b16 v[96:97], v4 offset:0
    ds_read_b64_tr_b16 v[98:99], v4 offset:512
    v_mfma_f32_16x16x32_bf16 v[64:67], v[112:115], v[84:87], v[64:67]
    ds_read_b64_tr_b16 v[100:101], v5 offset:0
    ds_read_b64_tr_b16 v[102:103], v5 offset:512
    v_mfma_f32_16x16x32_bf16 v[68:71], v[116:119], v[84:87], v[68:71]
    ds_read_b64_tr_b16 v[104:105], v6 offset:0
    ds_read_b64_tr_b16 v[106:107], v6 offset:512
    v_mfma_f32_16x16x32_bf16 v[72:75], v[120:123], v[84:87], v[72:75]
    ds_read_b64_tr_b16 v[108:109], v7 offset:0
    ds_read_b64_tr_b16 v[110:111], v7 offset:512
    v_mfma_f32_16x16x32_bf16 v[76:79], v[124:127], v[84:87], v[76:79]
    s_waitcnt lgkmcnt(8)
    v_cndmask_b32 v80, v80, v12, vcc
    v_cndmask_b32 v81, v81, v12, vcc
    v_cndmask_b32 v82, v82, v12, vcc
    v_cndmask_b32 v83, v83, v12, vcc
    s_nop 1
    ds_read_b64_tr_b16 v[112:113], v4 offset:8192
    ds_read_b64_tr_b16 v[114:115], v4 offset:8704
    s_waitcnt lgkmcnt(8)
    v_mfma_f32_16x16x32_bf16 v[32:35], v[96:99], v[80:83], v[32:35]
    ds_read_b64_tr_b16 v[116:117], v5 offset:8192
    ds_read_b64_tr_b16 v[118:119], v5 offset:8704
    s_waitcnt lgkmcnt(8)
    v_mfma_f32_16x16x32_bf16 v[36:39], v[100:103], v[80:83], v[36:39]
    ds_read_b64_tr_b16 v[120:121], v6 offset:8192
    ds_read_b64_tr_b16 v[122:123], v6 offset:8704
    s_waitcnt lgkmcnt(8)
    v_mfma_f32_16x16x32_bf16 v[40:43], v[104:107], v[80:83], v[40:43]
    ds_read_b64_tr_b16 v[124:125], v7 offset:8192
    ds_read_b64_tr_b16 v[126:127], v7 offset:8704
    s_waitcnt lgkmcnt(8)
    v_mfma_f32_16x16x32_bf16 v[44:47], v[108:111], v[80:83], v[44:47]
    ds_read_b64_tr_b16 v[96:97], v4 offset:16384
    ds_read_b64_tr_b16 v[98:99], v4 offset:16896
    s_waitcnt lgkmcnt(8)
    v_mfma_f32_16x16x32_bf16 v[48:51], v[112:115], v[80:83], v[48:51]
    ds_read_b64_tr_b16 v[100:101], v5 offset:16384
    ds_read_b64_tr_b16 v[102:103], v5 offset:16896
    s_waitcnt lgkmcnt(8)
    v_mfma_f32_16x16x32_bf16 v[52:55], v[116:119], v[80:83], v[52:55]
    ds_read_b64_tr_b16 v[104:105], v6 offset:16384
    ds_read_b64_tr_b16 v[106:107], v6 offset:16896
    s_waitcnt lgkmcnt(8)
    v_mfma_f32_16x16x32_bf16 v[56:59], v[120:123], v[80:83], v[56:59]
    ds_read_b64_tr_b16 v[108:109], v7 offset:16384
    ds_read_b64_tr_b16 v[110:111], v7 offset:16896
    s_waitcnt lgkmcnt(8)
    v_mfma_f32_16x16x32_bf16 v[60:63], v[124:127], v[80:83], v[60:63]
    ds_read_b128 v[84:87], v3
    ds_read_b64_tr_b16 v[112:113], v4 offset:4096
    ds_read_b64_tr_b16 v[114:115], v4 offset:4608
    s_waitcnt lgkmcnt(9)
    v_mfma_f32_16x16x32_bf16 v[64:67], v[96:99], v[80:83], v[64:67]
    ds_read_b64_tr_b16 v[116:117], v5 offset:4096
    ds_read_b64_tr_b16 v[118:119], v5 offset:4608
    s_waitcnt lgkmcnt(9)
    v_mfma_f32_16x16x32_bf16 v[68:71], v[100:103], v[80:83], v[68:71]
    ds_read_b64_tr_b16 v[120:121], v6 offset:4096
    ds_read_b64_tr_b16 v[122:123], v6 offset:4608
    s_waitcnt lgkmcnt(9)
    v_mfma_f32_16x16x32_bf16 v[72:75], v[104:107], v[80:83], v[72:75]
    ds_read_b64_tr_b16 v[124:125], v7 offset:4096
    ds_read_b64_tr_b16 v[126:127], v7 offset:4608
    s_waitcnt lgkmcnt(9)
    v_mfma_f32_16x16x32_bf16 v[76:79], v[108:111], v[80:83], v[76:79]
    s_waitcnt lgkmcnt(8)
    v_cndmask_b32 v84, v84, v12, vcc
    v_cndmask_b32 v85, v85, v12, vcc
    v_cndmask_b32 v86, v86, v12, vcc
    v_cndmask_b32 v87, v87, v12, vcc
    s_nop 1
    ds_read_b64_tr_b16 v[96:97], v4 offset:12288
    ds_read_b64_tr_b16 v[98:99], v4 offset:12800
    s_waitcnt lgkmcnt(8)
    v_mfma_f32_16x16x32_bf16 v[32:35], v[112:115], v[84:87], v[32:35]
    ds_read_b64_tr_b16 v[100:101], v5 offset:12288
    ds_read_b64_tr_b16 v[102:103], v5 offset:12800
    s_waitcnt lgkmcnt(8)
    v_mfma_f32_16x16x32_bf16 v[36:39], v[116:119], v[84:87], v[36:39]
    ds_read_b64_tr_b16 v[104:105], v6 offset:12288
    ds_read_b64_tr_b16 v[106:107], v6 offset:12800
    s_waitcnt lgkmcnt(8)
    v_mfma_f32_16x16x32_bf16 v[40:43], v[120:123], v[84:87], v[40:43]
    ds_read_b64_tr_b16 v[108:109], v7 offset:12288
    ds_read_b64_tr_b16 v[110:111], v7 offset:12800
    s_waitcnt lgkmcnt(8)
    v_mfma_f32_16x16x32_bf16 v[44:47], v[124:127], v[84:87], v[44:47]
    ds_read_b64_tr_b16 v[112:113], v4 offset:20480
    ds_read_b64_tr_b16 v[114:115], v4 offset:20992
    s_waitcnt lgkmcnt(8)
    v_mfma_f32_16x16x32_bf16 v[48:51], v[96:99], v[84:87], v[48:51]
    ds_read_b64_tr_b16 v[116:117], v5 offset:20480
    ds_read_b64_tr_b16 v[118:119], v5 offset:20992
    s_waitcnt lgkmcnt(8)
    v_mfma_f32_16x16x32_bf16 v[52:55], v[100:103], v[84:87], v[52:55]
    ds_read_b64_tr_b16 v[120:121], v6 offset:20480
    ds_read_b64_tr_b16 v[122:123], v6 offset:20992
    s_waitcnt lgkmcnt(8)
    v_mfma_f32_16x16x32_bf16 v[56:59], v[104:107], v[84:87], v[56:59]
    ds_read_b64_tr_b16 v[124:125], v7 offset:20480
    ds_read_b64_tr_b16 v[126:127], v7 offset:20992
    s_waitcnt lgkmcnt(8)
    v_mfma_f32_16x16x32_bf16 v[60:63], v[108:111], v[84:87], v[60:63]
    s_waitcnt lgkmcnt(0)
    v_add_u32 v2, 0xfffe6800, v2
    v_add_u32 v3, 0xfffe6800, v3
    v_add_u32 v4, 0xfffe6800, v4
    v_add_u32 v5, 0xfffe6800, v5
    v_add_u32 v6, 0xfffe6800, v6
    v_add_u32 v7, 0xfffe6800, v7
    s_barrier
    ds_read_b128 v[80:83], v2
    ds_read_b64_tr_b16 v[96:97], v4 offset:0
    ds_read_b64_tr_b16 v[98:99], v4 offset:512
    v_mfma_f32_16x16x32_bf16 v[64:67], v[112:115], v[84:87], v[64:67]
    ds_read_b64_tr_b16 v[100:101], v5 offset:0
    ds_read_b64_tr_b16 v[102:103], v5 offset:512
    v_mfma_f32_16x16x32_bf16 v[68:71], v[116:119], v[84:87], v[68:71]
    ds_read_b64_tr_b16 v[104:105], v6 offset:0
    ds_read_b64_tr_b16 v[106:107], v6 offset:512
    v_mfma_f32_16x16x32_bf16 v[72:75], v[120:123], v[84:87], v[72:75]
    ds_read_b64_tr_b16 v[108:109], v7 offset:0
    ds_read_b64_tr_b16 v[110:111], v7 offset:512
    v_mfma_f32_16x16x32_bf16 v[76:79], v[124:127], v[84:87], v[76:79]
    s_waitcnt lgkmcnt(8)
    v_cndmask_b32 v80, v80, v12, vcc
    v_cndmask_b32 v81, v81, v12, vcc
    v_cndmask_b32 v82, v82, v12, vcc
    v_cndmask_b32 v83, v83, v12, vcc
    s_nop 1
    ds_read_b64_tr_b16 v[112:113], v4 offset:8192
    ds_read_b64_tr_b16 v[114:115], v4 offset:8704
    s_waitcnt lgkmcnt(8)
    v_mfma_f32_16x16x32_bf16 v[32:35], v[96:99], v[80:83], v[32:35]
    ds_read_b64_tr_b16 v[116:117], v5 offset:8192
    ds_read_b64_tr_b16 v[118:119], v5 offset:8704
    s_waitcnt lgkmcnt(8)
    v_mfma_f32_16x16x32_bf16 v[36:39], v[100:103], v[80:83], v[36:39]
    ds_read_b64_tr_b16 v[120:121], v6 offset:8192
    ds_read_b64_tr_b16 v[122:123], v6 offset:8704
    s_waitcnt lgkmcnt(8)
    v_mfma_f32_16x16x32_bf16 v[40:43], v[104:107], v[80:83], v[40:43]
    ds_read_b64_tr_b16 v[124:125], v7 offset:8192
    ds_read_b64_tr_b16 v[126:127], v7 offset:8704
    s_waitcnt lgkmcnt(8)
    v_mfma_f32_16x16x32_bf16 v[44:47], v[108:111], v[80:83], v[44:47]
    ds_read_b64_tr_b16 v[96:97], v4 offset:16384
    ds_read_b64_tr_b16 v[98:99], v4 offset:16896
    s_waitcnt lgkmcnt(8)
    v_mfma_f32_16x16x32_bf16 v[48:51], v[112:115], v[80:83], v[48:51]
    ds_read_b64_tr_b16 v[100:101], v5 offset:16384
    ds_read_b64_tr_b16 v[102:103], v5 offset:16896
    s_waitcnt lgkmcnt(8)
    v_mfma_f32_16x16x32_bf16 v[52:55], v[116:119], v[80:83], v[52:55]
    ds_read_b64_tr_b16 v[104:105], v6 offset:16384
    ds_read_b64_tr_b16 v[106:107], v6 offset:16896
    s_waitcnt lgkmcnt(8)
    v_mfma_f32_16x16x32_bf16 v[56:59], v[120:123], v[80:83], v[56:59]
    ds_read_b64_tr_b16 v[108:109], v7 offset:16384
    ds_read_b64_tr_b16 v[110:111], v7 offset:16896
    s_waitcnt lgkmcnt(8)
    v_mfma_f32_16x16x32_bf16 v[60:63], v[124:127], v[80:83], v[60:63]
    ds_read_b128 v[84:87], v3
    ds_read_b64_tr_b16 v[112:113], v4 offset:4096
    ds_read_b64_tr_b16 v[114:115], v4 offset:4608
    s_waitcnt lgkmcnt(9)
    v_mfma_f32_16x16x32_bf16 v[64:67], v[96:99], v[80:83], v[64:67]
    ds_read_b64_tr_b16 v[116:117], v5 offset:4096
    ds_read_b64_tr_b16 v[118:119], v5 offset:4608
    s_waitcnt lgkmcnt(9)
    v_mfma_f32_16x16x32_bf16 v[68:71], v[100:103], v[80:83], v[68:71]
    ds_read_b64_tr_b16 v[120:121], v6 offset:4096
    ds_read_b64_tr_b16 v[122:123], v6 offset:4608
    s_waitcnt lgkmcnt(9)
    v_mfma_f32_16x16x32_bf16 v[72:75], v[104:107], v[80:83], v[72:75]
    ds_read_b64_tr_b16 v[124:125], v7 offset:4096
    ds_read_b64_tr_b16 v[126:127], v7 offset:4608
    s_waitcnt lgkmcnt(9)
    v_mfma_f32_16x16x32_bf16 v[76:79], v[108:111], v[80:83], v[76:79]
    s_waitcnt lgkmcnt(8)
    v_cndmask_b32 v84, v84, v12, vcc
    v_cndmask_b32 v85, v85, v12, vcc
    v_cndmask_b32 v86, v86, v12, vcc
    v_cndmask_b32 v87, v87, v12, vcc
    s_nop 1
    ds_read_b64_tr_b16 v[96:97], v4 offset:12288
    ds_read_b64_tr_b16 v[98:99], v4 offset:12800
    s_waitcnt lgkmcnt(8)
    v_mfma_f32_16x16x32_bf16 v[32:35], v[112:115], v[84:87], v[32:35]
    ds_read_b64_tr_b16 v[100:101], v5 offset:12288
    ds_read_b64_tr_b16 v[102:103], v5 offset:12800
    s_waitcnt lgkmcnt(8)
    v_mfma_f32_16x16x32_bf16 v[36:39], v[116:119], v[84:87], v[36:39]
    ds_read_b64_tr_b16 v[104:105], v6 offset:12288
    ds_read_b64_tr_b16 v[106:107], v6 offset:12800
    s_waitcnt lgkmcnt(8)
    v_mfma_f32_16x16x32_bf16 v[40:43], v[120:123], v[84:87], v[40:43]
    ds_read_b64_tr_b16 v[108:109], v7 offset:12288
    ds_read_b64_tr_b16 v[110:111], v7 offset:12800
    s_waitcnt lgkmcnt(8)
    v_mfma_f32_16x16x32_bf16 v[44:47], v[124:127], v[84:87], v[44:47]
    ds_read_b64_tr_b16 v[112:113], v4 offset:20480
    ds_read_b64_tr_b16 v[114:115], v4 offset:20992
    s_waitcnt lgkmcnt(8)
    v_mfma_f32_16x16x32_bf16 v[48:51], v[96:99], v[84:87], v[48:51]
    ds_read_b64_tr_b16 v[116:117], v5 offset:20480
    ds_read_b64_tr_b16 v[118:119], v5 offset:20992
    s_waitcnt lgkmcnt(8)
    v_mfma_f32_16x16x32_bf16 v[52:55], v[100:103], v[84:87], v[52:55]
    ds_read_b64_tr_b16 v[120:121], v6 offset:20480
    ds_read_b64_tr_b16 v[122:123], v6 offset:20992
    s_waitcnt lgkmcnt(8)
    v_mfma_f32_16x16x32_bf16 v[56:59], v[104:107], v[84:87], v[56:59]
    ds_read_b64_tr_b16 v[124:125], v7 offset:20480
    ds_read_b64_tr_b16 v[126:127], v7 offset:20992
    s_waitcnt lgkmcnt(8)
    v_mfma_f32_16x16x32_bf16 v[60:63], v[108:111], v[84:87], v[60:63]
    v_add_u32 v2, 0x8800, v2
    v_add_u32 v3, 0x8800, v3
    v_add_u32 v4, 0x8800, v4
    v_add_u32 v5, 0x8800, v5
    v_add_u32 v6, 0x8800, v6
    v_add_u32 v7, 0x8800, v7
    s_barrier
    ds_read_b128 v[80:83], v2
    ds_read_b64_tr_b16 v[96:97], v4 offset:0
    ds_read_b64_tr_b16 v[98:99], v4 offset:512
    s_waitcnt lgkmcnt(9)
    v_mfma_f32_16x16x32_bf16 v[64:67], v[112:115], v[84:87], v[64:67]
    ds_read_b64_tr_b16 v[100:101], v5 offset:0
    ds_read_b64_tr_b16 v[102:103], v5 offset:512
    s_waitcnt lgkmcnt(9)
    v_mfma_f32_16x16x32_bf16 v[68:71], v[116:119], v[84:87], v[68:71]
    ds_read_b64_tr_b16 v[104:105], v6 offset:0
    ds_read_b64_tr_b16 v[106:107], v6 offset:512
    s_waitcnt lgkmcnt(9)
    v_mfma_f32_16x16x32_bf16 v[72:75], v[120:123], v[84:87], v[72:75]
    ds_read_b64_tr_b16 v[108:109], v7 offset:0
    ds_read_b64_tr_b16 v[110:111], v7 offset:512
    s_waitcnt lgkmcnt(9)
    v_mfma_f32_16x16x32_bf16 v[76:79], v[124:127], v[84:87], v[76:79]
    s_waitcnt lgkmcnt(8)
    v_cndmask_b32 v80, v80, v12, vcc
    v_cndmask_b32 v81, v81, v12, vcc
    v_cndmask_b32 v82, v82, v12, vcc
    v_cndmask_b32 v83, v83, v12, vcc
    s_nop 1
    ds_read_b64_tr_b16 v[112:113], v4 offset:8192
    ds_read_b64_tr_b16 v[114:115], v4 offset:8704
    s_waitcnt lgkmcnt(8)
    v_mfma_f32_16x16x32_bf16 v[32:35], v[96:99], v[80:83], v[32:35]
    ds_read_b64_tr_b16 v[116:117], v5 offset:8192
    ds_read_b64_tr_b16 v[118:119], v5 offset:8704
    s_waitcnt lgkmcnt(8)
    v_mfma_f32_16x16x32_bf16 v[36:39], v[100:103], v[80:83], v[36:39]
    ds_read_b64_tr_b16 v[120:121], v6 offset:8192
    ds_read_b64_tr_b16 v[122:123], v6 offset:8704
    s_waitcnt lgkmcnt(8)
    v_mfma_f32_16x16x32_bf16 v[40:43], v[104:107], v[80:83], v[40:43]
    ds_read_b64_tr_b16 v[124:125], v7 offset:8192
    ds_read_b64_tr_b16 v[126:127], v7 offset:8704
    s_waitcnt lgkmcnt(8)
    v_mfma_f32_16x16x32_bf16 v[44:47], v[108:111], v[80:83], v[44:47]
    ds_read_b64_tr_b16 v[96:97], v4 offset:16384
    ds_read_b64_tr_b16 v[98:99], v4 offset:16896
    s_waitcnt lgkmcnt(8)
    v_mfma_f32_16x16x32_bf16 v[48:51], v[112:115], v[80:83], v[48:51]
    ds_read_b64_tr_b16 v[100:101], v5 offset:16384
    ds_read_b64_tr_b16 v[102:103], v5 offset:16896
    s_waitcnt lgkmcnt(8)
    v_mfma_f32_16x16x32_bf16 v[52:55], v[116:119], v[80:83], v[52:55]
    ds_read_b64_tr_b16 v[104:105], v6 offset:16384
    ds_read_b64_tr_b16 v[106:107], v6 offset:16896
    s_waitcnt lgkmcnt(8)
    v_mfma_f32_16x16x32_bf16 v[56:59], v[120:123], v[80:83], v[56:59]
    ds_read_b64_tr_b16 v[108:109], v7 offset:16384
    ds_read_b64_tr_b16 v[110:111], v7 offset:16896
    s_waitcnt lgkmcnt(8)
    v_mfma_f32_16x16x32_bf16 v[60:63], v[124:127], v[80:83], v[60:63]
    ds_read_b128 v[84:87], v3
    ds_read_b64_tr_b16 v[112:113], v4 offset:4096
    ds_read_b64_tr_b16 v[114:115], v4 offset:4608
    s_waitcnt lgkmcnt(9)
    v_mfma_f32_16x16x32_bf16 v[64:67], v[96:99], v[80:83], v[64:67]
    ds_read_b64_tr_b16 v[116:117], v5 offset:4096
    ds_read_b64_tr_b16 v[118:119], v5 offset:4608
    s_waitcnt lgkmcnt(9)
    v_mfma_f32_16x16x32_bf16 v[68:71], v[100:103], v[80:83], v[68:71]
    ds_read_b64_tr_b16 v[120:121], v6 offset:4096
    ds_read_b64_tr_b16 v[122:123], v6 offset:4608
    s_waitcnt lgkmcnt(9)
    v_mfma_f32_16x16x32_bf16 v[72:75], v[104:107], v[80:83], v[72:75]
    ds_read_b64_tr_b16 v[124:125], v7 offset:4096
    ds_read_b64_tr_b16 v[126:127], v7 offset:4608
    s_waitcnt lgkmcnt(9)
    v_mfma_f32_16x16x32_bf16 v[76:79], v[108:111], v[80:83], v[76:79]
    s_waitcnt lgkmcnt(8)
    v_cndmask_b32 v84, v84, v12, vcc
    v_cndmask_b32 v85, v85, v12, vcc
    v_cndmask_b32 v86, v86, v12, vcc
    v_cndmask_b32 v87, v87, v12, vcc
    s_nop 1
    ds_read_b64_tr_b16 v[96:97], v4 offset:12288
    ds_read_b64_tr_b16 v[98:99], v4 offset:12800
    s_waitcnt lgkmcnt(8)
    v_mfma_f32_16x16x32_bf16 v[32:35], v[112:115], v[84:87], v[32:35]
    ds_read_b64_tr_b16 v[100:101], v5 offset:12288
    ds_read_b64_tr_b16 v[102:103], v5 offset:12800
    s_waitcnt lgkmcnt(8)
    v_mfma_f32_16x16x32_bf16 v[36:39], v[116:119], v[84:87], v[36:39]
    ds_read_b64_tr_b16 v[104:105], v6 offset:12288
    ds_read_b64_tr_b16 v[106:107], v6 offset:12800
    s_waitcnt lgkmcnt(8)
    v_mfma_f32_16x16x32_bf16 v[40:43], v[120:123], v[84:87], v[40:43]
    ds_read_b64_tr_b16 v[108:109], v7 offset:12288
    ds_read_b64_tr_b16 v[110:111], v7 offset:12800
    s_waitcnt lgkmcnt(8)
    v_mfma_f32_16x16x32_bf16 v[44:47], v[124:127], v[84:87], v[44:47]
    ds_read_b64_tr_b16 v[112:113], v4 offset:20480
    ds_read_b64_tr_b16 v[114:115], v4 offset:20992
    s_waitcnt lgkmcnt(8)
    v_mfma_f32_16x16x32_bf16 v[48:51], v[96:99], v[84:87], v[48:51]
    ds_read_b64_tr_b16 v[116:117], v5 offset:20480
    ds_read_b64_tr_b16 v[118:119], v5 offset:20992
    s_waitcnt lgkmcnt(8)
    v_mfma_f32_16x16x32_bf16 v[52:55], v[100:103], v[84:87], v[52:55]
    ds_read_b64_tr_b16 v[120:121], v6 offset:20480
    ds_read_b64_tr_b16 v[122:123], v6 offset:20992
    s_waitcnt lgkmcnt(8)
    v_mfma_f32_16x16x32_bf16 v[56:59], v[104:107], v[84:87], v[56:59]
    ds_read_b64_tr_b16 v[124:125], v7 offset:20480
    ds_read_b64_tr_b16 v[126:127], v7 offset:20992
    s_waitcnt lgkmcnt(8)
    v_mfma_f32_16x16x32_bf16 v[60:63], v[108:111], v[84:87], v[60:63]
    v_add_u32 v2, 0x8800, v2
    v_add_u32 v3, 0x8800, v3
    v_add_u32 v4, 0x8800, v4
    v_add_u32 v5, 0x8800, v5
    v_add_u32 v6, 0x8800, v6
    v_add_u32 v7, 0x8800, v7
    s_barrier
    ds_read_b128 v[80:83], v2
    ds_read_b64_tr_b16 v[96:97], v4 offset:0
    ds_read_b64_tr_b16 v[98:99], v4 offset:512
    s_waitcnt lgkmcnt(9)
    v_mfma_f32_16x16x32_bf16 v[64:67], v[112:115], v[84:87], v[64:67]
    ds_read_b64_tr_b16 v[100:101], v5 offset:0
    ds_read_b64_tr_b16 v[102:103], v5 offset:512
    s_waitcnt lgkmcnt(9)
    v_mfma_f32_16x16x32_bf16 v[68:71], v[116:119], v[84:87], v[68:71]
    ds_read_b64_tr_b16 v[104:105], v6 offset:0
    ds_read_b64_tr_b16 v[106:107], v6 offset:512
    s_waitcnt lgkmcnt(9)
    v_mfma_f32_16x16x32_bf16 v[72:75], v[120:123], v[84:87], v[72:75]
    ds_read_b64_tr_b16 v[108:109], v7 offset:0
    ds_read_b64_tr_b16 v[110:111], v7 offset:512
    s_waitcnt lgkmcnt(9)
    v_mfma_f32_16x16x32_bf16 v[76:79], v[124:127], v[84:87], v[76:79]
    s_waitcnt lgkmcnt(8)
    v_cndmask_b32 v80, v80, v12, vcc
    v_cndmask_b32 v81, v81, v12, vcc
    v_cndmask_b32 v82, v82, v12, vcc
    v_cndmask_b32 v83, v83, v12, vcc
    s_nop 1
    ds_read_b64_tr_b16 v[112:113], v4 offset:8192
    ds_read_b64_tr_b16 v[114:115], v4 offset:8704
    s_waitcnt lgkmcnt(8)
    v_mfma_f32_16x16x32_bf16 v[32:35], v[96:99], v[80:83], v[32:35]
    ds_read_b64_tr_b16 v[116:117], v5 offset:8192
    ds_read_b64_tr_b16 v[118:119], v5 offset:8704
    s_waitcnt lgkmcnt(8)
    v_mfma_f32_16x16x32_bf16 v[36:39], v[100:103], v[80:83], v[36:39]
    ds_read_b64_tr_b16 v[120:121], v6 offset:8192
    ds_read_b64_tr_b16 v[122:123], v6 offset:8704
    s_waitcnt lgkmcnt(8)
    v_mfma_f32_16x16x32_bf16 v[40:43], v[104:107], v[80:83], v[40:43]
    ds_read_b64_tr_b16 v[124:125], v7 offset:8192
    ds_read_b64_tr_b16 v[126:127], v7 offset:8704
    s_waitcnt lgkmcnt(8)
    v_mfma_f32_16x16x32_bf16 v[44:47], v[108:111], v[80:83], v[44:47]
    ds_read_b64_tr_b16 v[96:97], v4 offset:16384
    ds_read_b64_tr_b16 v[98:99], v4 offset:16896
    s_waitcnt lgkmcnt(8)
    v_mfma_f32_16x16x32_bf16 v[48:51], v[112:115], v[80:83], v[48:51]
    ds_read_b64_tr_b16 v[100:101], v5 offset:16384
    ds_read_b64_tr_b16 v[102:103], v5 offset:16896
    s_waitcnt lgkmcnt(8)
    v_mfma_f32_16x16x32_bf16 v[52:55], v[116:119], v[80:83], v[52:55]
    ds_read_b64_tr_b16 v[104:105], v6 offset:16384
    ds_read_b64_tr_b16 v[106:107], v6 offset:16896
    s_waitcnt lgkmcnt(8)
    v_mfma_f32_16x16x32_bf16 v[56:59], v[120:123], v[80:83], v[56:59]
    ds_read_b64_tr_b16 v[108:109], v7 offset:16384
    ds_read_b64_tr_b16 v[110:111], v7 offset:16896
    s_waitcnt lgkmcnt(8)
    v_mfma_f32_16x16x32_bf16 v[60:63], v[124:127], v[80:83], v[60:63]
    ds_read_b128 v[84:87], v3
    ds_read_b64_tr_b16 v[112:113], v4 offset:4096
    ds_read_b64_tr_b16 v[114:115], v4 offset:4608
    s_waitcnt lgkmcnt(9)
    v_mfma_f32_16x16x32_bf16 v[64:67], v[96:99], v[80:83], v[64:67]
    ds_read_b64_tr_b16 v[116:117], v5 offset:4096
    ds_read_b64_tr_b16 v[118:119], v5 offset:4608
    s_waitcnt lgkmcnt(9)
    v_mfma_f32_16x16x32_bf16 v[68:71], v[100:103], v[80:83], v[68:71]
    ds_read_b64_tr_b16 v[120:121], v6 offset:4096
    ds_read_b64_tr_b16 v[122:123], v6 offset:4608
    s_waitcnt lgkmcnt(9)
    v_mfma_f32_16x16x32_bf16 v[72:75], v[104:107], v[80:83], v[72:75]
    ds_read_b64_tr_b16 v[124:125], v7 offset:4096
    ds_read_b64_tr_b16 v[126:127], v7 offset:4608
    s_waitcnt lgkmcnt(9)
    v_mfma_f32_16x16x32_bf16 v[76:79], v[108:111], v[80:83], v[76:79]
    s_waitcnt lgkmcnt(8)
    v_cndmask_b32 v84, v84, v12, vcc
    v_cndmask_b32 v85, v85, v12, vcc
    v_cndmask_b32 v86, v86, v12, vcc
    v_cndmask_b32 v87, v87, v12, vcc
    s_nop 1
    ds_read_b64_tr_b16 v[96:97], v4 offset:12288
    ds_read_b64_tr_b16 v[98:99], v4 offset:12800
    s_waitcnt lgkmcnt(8)
    v_mfma_f32_16x16x32_bf16 v[32:35], v[112:115], v[84:87], v[32:35]
    ds_read_b64_tr_b16 v[100:101], v5 offset:12288
    ds_read_b64_tr_b16 v[102:103], v5 offset:12800
    s_waitcnt lgkmcnt(8)
    v_mfma_f32_16x16x32_bf16 v[36:39], v[116:119], v[84:87], v[36:39]
    ds_read_b64_tr_b16 v[104:105], v6 offset:12288
    ds_read_b64_tr_b16 v[106:107], v6 offset:12800
    s_waitcnt lgkmcnt(8)
    v_mfma_f32_16x16x32_bf16 v[40:43], v[120:123], v[84:87], v[40:43]
    ds_read_b64_tr_b16 v[108:109], v7 offset:12288
    ds_read_b64_tr_b16 v[110:111], v7 offset:12800
    s_waitcnt lgkmcnt(8)
    v_mfma_f32_16x16x32_bf16 v[44:47], v[124:127], v[84:87], v[44:47]
    ds_read_b64_tr_b16 v[112:113], v4 offset:20480
    ds_read_b64_tr_b16 v[114:115], v4 offset:20992
    s_waitcnt lgkmcnt(8)
    v_mfma_f32_16x16x32_bf16 v[48:51], v[96:99], v[84:87], v[48:51]
    ds_read_b64_tr_b16 v[116:117], v5 offset:20480
    ds_read_b64_tr_b16 v[118:119], v5 offset:20992
    s_waitcnt lgkmcnt(8)
    v_mfma_f32_16x16x32_bf16 v[52:55], v[100:103], v[84:87], v[52:55]
    ds_read_b64_tr_b16 v[120:121], v6 offset:20480
    ds_read_b64_tr_b16 v[122:123], v6 offset:20992
    s_waitcnt lgkmcnt(8)
    v_mfma_f32_16x16x32_bf16 v[56:59], v[104:107], v[84:87], v[56:59]
    ds_read_b64_tr_b16 v[124:125], v7 offset:20480
    ds_read_b64_tr_b16 v[126:127], v7 offset:20992
    s_waitcnt lgkmcnt(8)
    v_mfma_f32_16x16x32_bf16 v[60:63], v[108:111], v[84:87], v[60:63]
    v_add_u32 v2, 0x8800, v2
    v_add_u32 v3, 0x8800, v3
    v_add_u32 v4, 0x8800, v4
    v_add_u32 v5, 0x8800, v5
    v_add_u32 v6, 0x8800, v6
    v_add_u32 v7, 0x8800, v7
    ds_read_b128 v[80:83], v2
    ds_read_b64_tr_b16 v[96:97], v4 offset:0
    ds_read_b64_tr_b16 v[98:99], v4 offset:512
    s_waitcnt lgkmcnt(9)
    v_mfma_f32_16x16x32_bf16 v[64:67], v[112:115], v[84:87], v[64:67]
    ds_read_b64_tr_b16 v[100:101], v5 offset:0
    ds_read_b64_tr_b16 v[102:103], v5 offset:512
    s_waitcnt lgkmcnt(9)
    v_mfma_f32_16x16x32_bf16 v[68:71], v[116:119], v[84:87], v[68:71]
    ds_read_b64_tr_b16 v[104:105], v6 offset:0
    ds_read_b64_tr_b16 v[106:107], v6 offset:512
    s_waitcnt lgkmcnt(9)
    v_mfma_f32_16x16x32_bf16 v[72:75], v[120:123], v[84:87], v[72:75]
    ds_read_b64_tr_b16 v[108:109], v7 offset:0
    ds_read_b64_tr_b16 v[110:111], v7 offset:512
    s_waitcnt lgkmcnt(9)
    v_mfma_f32_16x16x32_bf16 v[76:79], v[124:127], v[84:87], v[76:79]
    s_waitcnt lgkmcnt(8)
    v_cndmask_b32 v80, v80, v12, vcc
    v_cndmask_b32 v81, v81, v12, vcc
    v_cndmask_b32 v82, v82, v12, vcc
    v_cndmask_b32 v83, v83, v12, vcc
    s_nop 1
    ds_read_b64_tr_b16 v[112:113], v4 offset:8192
    ds_read_b64_tr_b16 v[114:115], v4 offset:8704
    s_waitcnt lgkmcnt(8)
    v_mfma_f32_16x16x32_bf16 v[32:35], v[96:99], v[80:83], v[32:35]
    ds_read_b64_tr_b16 v[116:117], v5 offset:8192
    ds_read_b64_tr_b16 v[118:119], v5 offset:8704
    s_waitcnt lgkmcnt(8)
    v_mfma_f32_16x16x32_bf16 v[36:39], v[100:103], v[80:83], v[36:39]
    ds_read_b64_tr_b16 v[120:121], v6 offset:8192
    ds_read_b64_tr_b16 v[122:123], v6 offset:8704
    s_waitcnt lgkmcnt(8)
    v_mfma_f32_16x16x32_bf16 v[40:43], v[104:107], v[80:83], v[40:43]
    ds_read_b64_tr_b16 v[124:125], v7 offset:8192
    ds_read_b64_tr_b16 v[126:127], v7 offset:8704
    s_waitcnt lgkmcnt(8)
    v_mfma_f32_16x16x32_bf16 v[44:47], v[108:111], v[80:83], v[44:47]
    ds_read_b64_tr_b16 v[96:97], v4 offset:16384
    ds_read_b64_tr_b16 v[98:99], v4 offset:16896
    s_waitcnt lgkmcnt(8)
    v_mfma_f32_16x16x32_bf16 v[48:51], v[112:115], v[80:83], v[48:51]
    ds_read_b64_tr_b16 v[100:101], v5 offset:16384
    ds_read_b64_tr_b16 v[102:103], v5 offset:16896
    s_waitcnt lgkmcnt(8)
    v_mfma_f32_16x16x32_bf16 v[52:55], v[116:119], v[80:83], v[52:55]
    ds_read_b64_tr_b16 v[104:105], v6 offset:16384
    ds_read_b64_tr_b16 v[106:107], v6 offset:16896
    s_waitcnt lgkmcnt(8)
    v_mfma_f32_16x16x32_bf16 v[56:59], v[120:123], v[80:83], v[56:59]
    ds_read_b64_tr_b16 v[108:109], v7 offset:16384
    ds_read_b64_tr_b16 v[110:111], v7 offset:16896
    s_waitcnt lgkmcnt(8)
    v_mfma_f32_16x16x32_bf16 v[60:63], v[124:127], v[80:83], v[60:63]
    ds_read_b128 v[84:87], v3
    ds_read_b64_tr_b16 v[112:113], v4 offset:4096
    ds_read_b64_tr_b16 v[114:115], v4 offset:4608
    s_waitcnt lgkmcnt(9)
    v_mfma_f32_16x16x32_bf16 v[64:67], v[96:99], v[80:83], v[64:67]
    ds_read_b64_tr_b16 v[116:117], v5 offset:4096
    ds_read_b64_tr_b16 v[118:119], v5 offset:4608
    s_waitcnt lgkmcnt(9)
    v_mfma_f32_16x16x32_bf16 v[68:71], v[100:103], v[80:83], v[68:71]
    ds_read_b64_tr_b16 v[120:121], v6 offset:4096
    ds_read_b64_tr_b16 v[122:123], v6 offset:4608
    s_waitcnt lgkmcnt(9)
    v_mfma_f32_16x16x32_bf16 v[72:75], v[104:107], v[80:83], v[72:75]
    ds_read_b64_tr_b16 v[124:125], v7 offset:4096
    ds_read_b64_tr_b16 v[126:127], v7 offset:4608
    s_waitcnt lgkmcnt(9)
    v_mfma_f32_16x16x32_bf16 v[76:79], v[108:111], v[80:83], v[76:79]
    s_waitcnt lgkmcnt(8)
    v_cndmask_b32 v84, v84, v12, vcc
    v_cndmask_b32 v85, v85, v12, vcc
    v_cndmask_b32 v86, v86, v12, vcc
    v_cndmask_b32 v87, v87, v12, vcc
    s_nop 1
    ds_read_b64_tr_b16 v[96:97], v4 offset:12288
    ds_read_b64_tr_b16 v[98:99], v4 offset:12800
    s_waitcnt lgkmcnt(8)
    v_mfma_f32_16x16x32_bf16 v[32:35], v[112:115], v[84:87], v[32:35]
    ds_read_b64_tr_b16 v[100:101], v5 offset:12288
    ds_read_b64_tr_b16 v[102:103], v5 offset:12800
    s_waitcnt lgkmcnt(8)
    v_mfma_f32_16x16x32_bf16 v[36:39], v[116:119], v[84:87], v[36:39]
    ds_read_b64_tr_b16 v[104:105], v6 offset:12288
    ds_read_b64_tr_b16 v[106:107], v6 offset:12800
    s_waitcnt lgkmcnt(8)
    v_mfma_f32_16x16x32_bf16 v[40:43], v[120:123], v[84:87], v[40:43]
    ds_read_b64_tr_b16 v[108:109], v7 offset:12288
    ds_read_b64_tr_b16 v[110:111], v7 offset:12800
    s_waitcnt lgkmcnt(8)
    v_mfma_f32_16x16x32_bf16 v[44:47], v[124:127], v[84:87], v[44:47]
    ds_read_b64_tr_b16 v[112:113], v4 offset:20480
    ds_read_b64_tr_b16 v[114:115], v4 offset:20992
    s_waitcnt lgkmcnt(8)
    v_mfma_f32_16x16x32_bf16 v[48:51], v[96:99], v[84:87], v[48:51]
    ds_read_b64_tr_b16 v[116:117], v5 offset:20480
    ds_read_b64_tr_b16 v[118:119], v5 offset:20992
    s_waitcnt lgkmcnt(8)
    v_mfma_f32_16x16x32_bf16 v[52:55], v[100:103], v[84:87], v[52:55]
    ds_read_b64_tr_b16 v[120:121], v6 offset:20480
    ds_read_b64_tr_b16 v[122:123], v6 offset:20992
    s_waitcnt lgkmcnt(8)
    v_mfma_f32_16x16x32_bf16 v[56:59], v[104:107], v[84:87], v[56:59]
    ds_read_b64_tr_b16 v[124:125], v7 offset:20480
    ds_read_b64_tr_b16 v[126:127], v7 offset:20992
    s_waitcnt lgkmcnt(8)
    v_mfma_f32_16x16x32_bf16 v[60:63], v[108:111], v[84:87], v[60:63]
    s_waitcnt lgkmcnt(6)
    v_mfma_f32_16x16x32_bf16 v[64:67], v[112:115], v[84:87], v[64:67]
    s_waitcnt lgkmcnt(4)
    v_mfma_f32_16x16x32_bf16 v[68:71], v[116:119], v[84:87], v[68:71]
    s_waitcnt lgkmcnt(2)
    v_mfma_f32_16x16x32_bf16 v[72:75], v[120:123], v[84:87], v[72:75]
    s_waitcnt lgkmcnt(0)
    v_mfma_f32_16x16x32_bf16 v[76:79], v[124:127], v[84:87], v[76:79]
    v_lshrrev_b32 v9, 4, v1
    v_and_b32 v10, 15, v1
    v_lshlrev_b32 v2, 4, v9
    v_add_u32 v2, 139264, v2
    v_lshlrev_b32 v3, 3, v10
    v_add_u32 v3, 140288, v3
    v_mul_u32_u24 v4, 144, v10
    v_lshl_add_u32 v4, v9, 3, v4
    v_mul_u32_u24 v5, 272, v10
    v_lshl_add_u32 v5, v9, 4, v5
    s_and_saveexec_b64 s[70:71], vcc
    ds_write_b128 v2, v[32:35] offset:0
    ds_write_b128 v2, v[36:39] offset:64
    ds_write_b128 v2, v[40:43] offset:128
    ds_write_b128 v2, v[44:47] offset:192
    ds_write_b128 v2, v[48:51] offset:256
    ds_write_b128 v2, v[52:55] offset:320
    ds_write_b128 v2, v[56:59] offset:384
    ds_write_b128 v2, v[60:63] offset:448
    ds_write_b128 v2, v[64:67] offset:512
    ds_write_b128 v2, v[68:71] offset:576
    ds_write_b128 v2, v[72:75] offset:640
    ds_write_b128 v2, v[76:79] offset:704
    s_mov_b64 exec, s[70:71]
    s_waitcnt lgkmcnt(0)
    s_barrier
    ds_read_b64 v[80:81], v3
    ds_read_b128 v[96:99], v2 offset:256
    ds_read_b128 v[100:103], v2 offset:320
    ds_read_b128 v[104:107], v2 offset:384
    ds_read_b128 v[108:111], v2 offset:448
    ds_read_b128 v[112:115], v2 offset:512
    ds_read_b128 v[116:119], v2 offset:576
    ds_read_b128 v[120:123], v2 offset:640
    ds_read_b128 v[124:127], v2 offset:704
    s_waitcnt lgkmcnt(7)
    v_pk_fma_f32 v[48:49], v[96:97], v[80:81], v[48:49] op_sel_hi:[1,0,1]
    v_pk_fma_f32 v[50:51], v[98:99], v[80:81], v[50:51] op_sel_hi:[1,0,1]
    v_pk_mul_f32 v[48:49], v[48:49], v[80:81] op_sel:[0,1] op_sel_hi:[1,1]
    v_pk_mul_f32 v[50:51], v[50:51], v[80:81] op_sel:[0,1] op_sel_hi:[1,1]
    v_cvt_pk_bf16_f32 v48, v48, v49
    v_cvt_pk_bf16_f32 v49, v50, v51
    ds_write_b64 v4, v[48:49] offset:9216
    s_waitcnt lgkmcnt(7)
    v_pk_fma_f32 v[52:53], v[100:101], v[80:81], v[52:53] op_sel_hi:[1,0,1]
    v_pk_fma_f32 v[54:55], v[102:103], v[80:81], v[54:55] op_sel_hi:[1,0,1]
    v_pk_mul_f32 v[52:53], v[52:53], v[80:81] op_sel:[0,1] op_sel_hi:[1,1]
    v_pk_mul_f32 v[54:55], v[54:55], v[80:81] op_sel:[0,1] op_sel_hi:[1,1]
    v_cvt_pk_bf16_f32 v52, v52, v53
    v_cvt_pk_bf16_f32 v53, v54, v55
    ds_write_b64 v4, v[52:53] offset:9248
    s_waitcnt lgkmcnt(7)
    v_pk_fma_f32 v[56:57], v[104:105], v[80:81], v[56:57] op_sel_hi:[1,0,1]
    v_pk_fma_f32 v[58:59], v[106:107], v[80:81], v[58:59] op_sel_hi:[1,0,1]
    v_pk_mul_f32 v[56:57], v[56:57], v[80:81] op_sel:[0,1] op_sel_hi:[1,1]
    v_pk_mul_f32 v[58:59], v[58:59], v[80:81] op_sel:[0,1] op_sel_hi:[1,1]
    v_cvt_pk_bf16_f32 v56, v56, v57
    v_cvt_pk_bf16_f32 v57, v58, v59
    ds_write_b64 v4, v[56:57] offset:9280
    s_waitcnt lgkmcnt(7)
    v_pk_fma_f32 v[60:61], v[108:109], v[80:81], v[60:61] op_sel_hi:[1,0,1]
    v_pk_fma_f32 v[62:63], v[110:111], v[80:81], v[62:63] op_sel_hi:[1,0,1]
    v_pk_mul_f32 v[60:61], v[60:61], v[80:81] op_sel:[0,1] op_sel_hi:[1,1]
    v_pk_mul_f32 v[62:63], v[62:63], v[80:81] op_sel:[0,1] op_sel_hi:[1,1]
    v_cvt_pk_bf16_f32 v60, v60, v61
    v_cvt_pk_bf16_f32 v61, v62, v63
    ds_write_b64 v4, v[60:61] offset:9312
    s_waitcnt lgkmcnt(7)
    v_pk_fma_f32 v[64:65], v[112:113], v[80:81], v[64:65] op_sel_hi:[1,0,1]
    v_pk_fma_f32 v[66:67], v[114:115], v[80:81], v[66:67] op_sel_hi:[1,0,1]
    v_pk_mul_f32 v[64:65], v[64:65], v[80:81] op_sel:[0,1] op_sel_hi:[1,1]
    v_pk_mul_f32 v[66:67], v[66:67], v[80:81] op_sel:[0,1] op_sel_hi:[1,1]
    ds_write_b128 v5, v[64:67] offset:20736
    s_waitcnt lgkmcnt(7)
    v_pk_fma_f32 v[68:69], v[116:117], v[80:81], v[68:69] op_sel_hi:[1,0,1]
    v_pk_fma_f32 v[70:71], v[118:119], v[80:81], v[70:71] op_sel_hi:[1,0,1]
    v_pk_mul_f32 v[68:69], v[68:69], v[80:81] op_sel:[0,1] op_sel_hi:[1,1]
    v_pk_mul_f32 v[70:71], v[70:71], v[80:81] op_sel:[0,1] op_sel_hi:[1,1]
    ds_write_b128 v5, v[68:71] offset:20800
    s_waitcnt lgkmcnt(7)
    v_pk_fma_f32 v[72:73], v[120:121], v[80:81], v[72:73] op_sel_hi:[1,0,1]
    v_pk_fma_f32 v[74:75], v[122:123], v[80:81], v[74:75] op_sel_hi:[1,0,1]
    v_pk_mul_f32 v[72:73], v[72:73], v[80:81] op_sel:[0,1] op_sel_hi:[1,1]
    v_pk_mul_f32 v[74:75], v[74:75], v[80:81] op_sel:[0,1] op_sel_hi:[1,1]
    ds_write_b128 v5, v[72:75] offset:20864
    s_waitcnt lgkmcnt(7)
    v_pk_fma_f32 v[76:77], v[124:125], v[80:81], v[76:77] op_sel_hi:[1,0,1]
    v_pk_fma_f32 v[78:79], v[126:127], v[80:81], v[78:79] op_sel_hi:[1,0,1]
    v_pk_mul_f32 v[76:77], v[76:77], v[80:81] op_sel:[0,1] op_sel_hi:[1,1]
    v_pk_mul_f32 v[78:79], v[78:79], v[80:81] op_sel:[0,1] op_sel_hi:[1,1]
    ds_write_b128 v5, v[76:79] offset:20928
    s_branch p1att_4
p1l_3:
    s_setprio 0
    s_sub_u32 s66, s3, 4
    s_and_b32 s67, s66, 1
    s_add_u32 s67, s67, 8
    s_lshl_b32 s63, s67, 10
    s_and_b32 s7, s67, 1
    s_lshl_b32 s7, s7, 6
    v_xor_b32 v207, s7, v210
    s_lshl_b32 s6, s10, 16
    s_lshl_b32 s7, s67, 13
    s_add_u32 s6, s6, s7
    s_sub_u32 s6, s6, 0x4000
    s_lshl_b32 s8, s4, 14
    s_add_u32 s8, s8, s7
    s_add_u32 s8, s8, 3129344
    s_cmp_lt_u32 s67, 2
    s_cselect_b32 s7, s65, 0
    s_cmp_lg_u32 s7, 0
    s_cselect_b32 s6, s8, s6
    v_add_u32 v207, s6, v207
    s_add_u32 m0, s62, 0x0
    s_nop 0
    buffer_load_dwordx4 v206, s[16:19], 0 offen sc1 lds
    s_add_u32 m0, s63, 0x0
    s_nop 0
    buffer_load_dwordx4 v207, s[16:19], 0 offen sc1 lds
    s_cmp_lg_u32 s100, 0
    s_cbranch_scc1 ifl_22
    s_add_u32 m0, s56, 0x8800
    s_mov_b32 s9, 0x30000
    buffer_load_dwordx4 v200, s[20:23], s9 offen lds
    s_add_u32 m0, s57, 0x8800
    s_mov_b32 s9, 0x30000
    buffer_load_dwordx4 v201, s[20:23], s9 offen lds
    s_add_u32 m0, s58, 0x8800
    s_mov_b32 s9, 0x30000
    buffer_load_dwordx4 v202, s[20:23], s9 offen lds
ifl_22:
    s_add_u32 m0, s62, 0x8800
    s_mov_b32 s9, 0x80
    buffer_load_dwordx4 v206, s[16:19], s9 offen sc1 lds
    s_add_u32 m0, s63, 0x8800
    s_mov_b32 s9, 0x80
    buffer_load_dwordx4 v207, s[16:19], s9 offen sc1 lds
    s_cmp_lg_u32 s100, 0
    s_cbranch_scc1 ifl_23
    s_add_u32 m0, s56, 0x11000
    s_mov_b32 s9, 0x60000
    buffer_load_dwordx4 v200, s[20:23], s9 offen lds
    s_add_u32 m0, s57, 0x11000
    s_mov_b32 s9, 0x60000
    buffer_load_dwordx4 v201, s[20:23], s9 offen lds
    s_add_u32 m0, s58, 0x11000
    s_mov_b32 s9, 0x60000
    buffer_load_dwordx4 v202, s[20:23], s9 offen lds
ifl_23:
    s_add_u32 m0, s62, 0x11000
    s_mov_b32 s9, 0x100
    buffer_load_dwordx4 v206, s[16:19], s9 offen sc1 lds
    s_add_u32 m0, s63, 0x11000
    s_mov_b32 s9, 0x100
    buffer_load_dwordx4 v207, s[16:19], s9 offen sc1 lds
    s_mul_i32 s6, s66, 3
    s_add_u32 s6, s6, 0
    s_lshl_b32 s59, s6, 10
    s_add_u32 s59, s59, 10240
    s_and_b32 s7, s6, 1
    s_lshl_b32 s7, s7, 5
    v_xor_b32 v203, s7, v209
    s_and_b32 s7, s6, 7
    s_mul_i32 s7, s7, 24576
    s_lshr_b32 s6, s6, 3
    s_lshl_b32 s6, s6, 10
    s_add_u32 s6, s6, s7
    v_add_u32 v203, s6, v203
    s_mul_i32 s6, s66, 3
    s_add_u32 s6, s6, 1
    s_lshl_b32 s60, s6, 10
    s_add_u32 s60, s60, 10240
    s_and_b32 s7, s6, 1
    s_lshl_b32 s7, s7, 5
    v_xor_b32 v204, s7, v209
    s_and_b32 s7, s6, 7
    s_mul_i32 s7, s7, 24576
    s_lshr_b32 s6, s6, 3
    s_lshl_b32 s6, s6, 10
    s_add_u32 s6, s6, s7
    v_add_u32 v204, s6, v204
    s_mul_i32 s6, s66, 3
    s_add_u32 s6, s6, 2
    s_lshl_b32 s61, s6, 10
    s_add_u32 s61, s61, 10240
    s_and_b32 s7, s6, 1
    s_lshl_b32 s7, s7, 5
    v_xor_b32 v205, s7, v209
    s_and_b32 s7, s6, 7
    s_mul_i32 s7, s7, 24576
    s_lshr_b32 s6, s6, 3
    s_lshl_b32 s6, s6, 10
    s_add_u32 s6, s6, s7
    v_add_u32 v205, s6, v205
    s_lshl_b32 s64, s66, 10
    s_and_b32 s7, s66, 1
    s_lshl_b32 s7, s7, 6
    v_xor_b32 v208, s7, v210
    s_lshl_b32 s6, s10, 16
    s_lshl_b32 s7, s66, 13
    s_add_u32 s6, s6, s7
    s_sub_u32 s6, s6, 0x4000
    s_lshl_b32 s8, s4, 14
    s_add_u32 s8, s8, s7
    s_add_u32 s8, s8, 3129344
    s_cmp_lt_u32 s66, 2
    s_cselect_b32 s7, s65, 0
    s_cmp_lg_u32 s7, 0
    s_cselect_b32 s6, s8, s6
    v_add_u32 v208, s6, v208
    s_min_u32 s8, s66, 2
    s_lshl_b32 s8, s8, 5
    s_sub_u32 s8, s8, 16
    s_max_i32 s8, s8, 0
    v_and_b32 v9, 31, v1
    v_lshrrev_b32 v10, 5, v1
    v_add_u32 v9, s8, v9
    v_bfe_u32 v11, v9, 1, 3
    v_xor_b32 v10, v10, v11
    v_lshlrev_b32 v10, 4, v10
    v_lshl_add_u32 v2, v9, 7, v10
    v_xor_b32 v3, 32, v2
    v_xor_b32 v4, 64, v2
    v_xor_b32 v5, 96, v2
    v_lshlrev_b32 v6, 3, v9
    v_add_u32 v6, 140288, v6
    v_mov_b32 v12, 0
    v_mov_b32 v13, 0
    v_mov_b32 v14, 0
    v_mov_b32 v15, 0
    s_cmp_eq_u32 s100, 0
    s_cbranch_scc1 w0_24
    s_waitcnt vmcnt(4)
    s_branch w1_25
w0_24:
    s_waitcnt vmcnt(10)
w1_25:
    s_barrier
    s_add_u32 m0, s62, 0x19800
    s_mov_b32 s9, 0x180
    buffer_load_dwordx4 v206, s[16:19], s9 offen sc1 lds
    s_add_u32 m0, s63, 0x19800
    s_mov_b32 s9, 0x180
    buffer_load_dwordx4 v207, s[16:19], s9 offen sc1 lds
    s_add_u32 m0, s64, 0x19800
    s_mov_b32 s9, 0x180
    buffer_load_dwordx4 v208, s[16:19], s9 offen sc1 lds
    s_add_u32 m0, s56, 0x19800
    s_mov_b32 s9, 0x90000
    buffer_load_dwordx4 v200, s[20:23], s9 offen lds
    s_add_u32 m0, s57, 0x19800
    s_mov_b32 s9, 0x90000
    buffer_load_dwordx4 v201, s[20:23], s9 offen lds
    s_add_u32 m0, s58, 0x19800
    s_mov_b32 s9, 0x90000
    buffer_load_dwordx4 v202, s[20:23], s9 offen lds
    s_add_u32 m0, s59, 0x19800
    s_mov_b32 s9, 0x90000
    buffer_load_dwordx4 v203, s[20:23], s9 offen lds
    s_add_u32 m0, s60, 0x19800
    s_mov_b32 s9, 0x90000
    buffer_load_dwordx4 v204, s[20:23], s9 offen lds
    s_add_u32 m0, s61, 0x19800
    s_mov_b32 s9, 0x90000
    buffer_load_dwordx4 v205, s[20:23], s9 offen lds
    s_cmp_eq_u32 s66, 3
    s_cbranch_scc1 nost_26
    ds_read_b128 v[32:35], v2
    ds_read_b128 v[36:39], v3
    ds_read_b128 v[40:43], v4
    ds_read_b128 v[44:47], v5
    v_add_u32 v2, 0x8800, v2
    v_add_u32 v3, 0x8800, v3
    v_add_u32 v4, 0x8800, v4
    v_add_u32 v5, 0x8800, v5
    s_waitcnt lgkmcnt(3)
    v_dot2_f32_bf16 v12, v32, s15, v12
    v_dot2_f32_bf16 v14, v32, v32, v14
    v_dot2_f32_bf16 v13, v33, s15, v13
    v_dot2_f32_bf16 v15, v33, v33, v15
    v_dot2_f32_bf16 v12, v34, s15, v12
    v_dot2_f32_bf16 v14, v34, v34, v14
    v_dot2_f32_bf16 v13, v35, s15, v13
    v_dot2_f32_bf16 v15, v35, v35, v15
    s_waitcnt lgkmcnt(2)
    v_dot2_f32_bf16 v12, v36, s15, v12
    v_dot2_f32_bf16 v14, v36, v36, v14
    v_dot2_f32_bf16 v13, v37, s15, v13
    v_dot2_f32_bf16 v15, v37, v37, v15
    v_dot2_f32_bf16 v12, v38, s15, v12
    v_dot2_f32_bf16 v14, v38, v38, v14
    v_dot2_f32_bf16 v13, v39, s15, v13
    v_dot2_f32_bf16 v15, v39, v39, v15
    s_waitcnt lgkmcnt(1)
    v_dot2_f32_bf16 v12, v40, s15, v12
    v_dot2_f32_bf16 v14, v40, v40, v14
    v_dot2_f32_bf16 v13, v41, s15, v13
    v_dot2_f32_bf16 v15, v41, v41, v15
    v_dot2_f32_bf16 v12, v42, s15, v12
    v_dot2_f32_bf16 v14, v42, v42, v14
    v_dot2_f32_bf16 v13, v43, s15, v13
    v_dot2_f32_bf16 v15, v43, v43, v15
    s_waitcnt lgkmcnt(0)
    v_dot2_f32_bf16 v12, v44, s15, v12
    v_dot2_f32_bf16 v14, v44, v44, v14
    v_dot2_f32_bf16 v13, v45, s15, v13
    v_dot2_f32_bf16 v15, v45, v45, v15
    v_dot2_f32_bf16 v12, v46, s15, v12
    v_dot2_f32_bf16 v14, v46, v46, v14
    v_dot2_f32_bf16 v13, v47, s15, v13
    v_dot2_f32_bf16 v15, v47, v47, v15
nost_26:
    s_cmp_eq_u32 s100, 0
    s_cbranch_scc1 w0_27
    s_waitcnt vmcnt(11)
    s_branch w1_28
w0_27:
    s_waitcnt vmcnt(14)
w1_28:
    s_barrier
    s_add_u32 m0, s62, 0x0
    s_mov_b32 s9, 0x200
    buffer_load_dwordx4 v206, s[16:19], s9 offen sc1 lds
    s_add_u32 m0, s63, 0x0
    s_mov_b32 s9, 0x200
    buffer_load_dwordx4 v207, s[16:19], s9 offen sc1 lds
    s_add_u32 m0, s64, 0x0
    s_mov_b32 s9, 0x200
    buffer_load_dwordx4 v208, s[16:19], s9 offen sc1 lds
    s_add_u32 m0, s56, 0x0
    s_mov_b32 s9, 0xc0000
    buffer_load_dwordx4 v200, s[20:23], s9 offen lds
    s_add_u32 m0, s57, 0x0
    s_mov_b32 s9, 0xc0000
    buffer_load_dwordx4 v201, s[20:23], s9 offen lds
    s_add_u32 m0, s58, 0x0
    s_mov_b32 s9, 0xc0000
    buffer_load_dwordx4 v202, s[20:23], s9 offen lds
    s_add_u32 m0, s59, 0x0
    s_mov_b32 s9, 0xc0000
    buffer_load_dwordx4 v203, s[20:23], s9 offen lds
    s_add_u32 m0, s60, 0x0
    s_mov_b32 s9, 0xc0000
    buffer_load_dwordx4 v204, s[20:23], s9 offen lds
    s_add_u32 m0, s61, 0x0
    s_mov_b32 s9, 0xc0000
    buffer_load_dwordx4 v205, s[20:23], s9 offen lds
    s_mov_b32 s32, s38
    s_mov_b32 s33, s39
    s_mov_b32 s34, 0x180000
    s_mov_b32 s35, 0x20000
    s_mov_b32 s6, 589824
    s_mul_i32 s7, s5, 30720
    s_add_u32 s6, s6, s7
    s_mul_i32 s7, s66, 7680
    s_add_u32 s6, s6, s7
    v_min_u32 v7, 59, v1
    v_lshl_add_u32 v7, v7, 7, s6
    buffer_load_dword v240, v7, s[32:35], 0 offen
    s_cmp_eq_u32 s66, 3
    s_cbranch_scc1 nost_29
    ds_read_b128 v[32:35], v2
    ds_read_b128 v[36:39], v3
    ds_read_b128 v[40:43], v4
    ds_read_b128 v[44:47], v5
    v_add_u32 v2, 0x8800, v2
    v_add_u32 v3, 0x8800, v3
    v_add_u32 v4, 0x8800, v4
    v_add_u32 v5, 0x8800, v5
    s_waitcnt lgkmcnt(3)
    v_dot2_f32_bf16 v12, v32, s15, v12
    v_dot2_f32_bf16 v14, v32, v32, v14
    v_dot2_f32_bf16 v13, v33, s15, v13
    v_dot2_f32_bf16 v15, v33, v33, v15
    v_dot2_f32_bf16 v12, v34, s15, v12
    v_dot2_f32_bf16 v14, v34, v34, v14
    v_dot2_f32_bf16 v13, v35, s15, v13
    v_dot2_f32_bf16 v15, v35, v35, v15
    s_waitcnt lgkmcnt(2)
    v_dot2_f32_bf16 v12, v36, s15, v12
    v_dot2_f32_bf16 v14, v36, v36, v14
    v_dot2_f32_bf16 v13, v37, s15, v13
    v_dot2_f32_bf16 v15, v37, v37, v15
    v_dot2_f32_bf16 v12, v38, s15, v12
    v_dot2_f32_bf16 v14, v38, v38, v14
    v_dot2_f32_bf16 v13, v39, s15, v13
    v_dot2_f32_bf16 v15, v39, v39, v15
    s_waitcnt lgkmcnt(1)
    v_dot2_f32_bf16 v12, v40, s15, v12
    v_dot2_f32_bf16 v14, v40, v40, v14
    v_dot2_f32_bf16 v13, v41, s15, v13
    v_dot2_f32_bf16 v15, v41, v41, v15
    v_dot2_f32_bf16 v12, v42, s15, v12
    v_dot2_f32_bf16 v14, v42, v42, v14
    v_dot2_f32_bf16 v13, v43, s15, v13
    v_dot2_f32_bf16 v15, v43, v43, v15
    s_waitcnt lgkmcnt(0)
    v_dot2_f32_bf16 v12, v44, s15, v12
    v_dot2_f32_bf16 v14, v44, v44, v14
    v_dot2_f32_bf16 v13, v45, s15, v13
    v_dot2_f32_bf16 v15, v45, v45, v15
    v_dot2_f32_bf16 v12, v46, s15, v12
    v_dot2_f32_bf16 v14, v46, v46, v14
    v_dot2_f32_bf16 v13, v47, s15, v13
    v_dot2_f32_bf16 v15, v47, v47, v15
nost_29:
    s_waitcnt vmcnt(19)
    s_barrier
    s_add_u32 m0, s62, 0x8800
    s_mov_b32 s9, 0x280
    buffer_load_dwordx4 v206, s[16:19], s9 offen sc1 lds
    s_add_u32 m0, s63, 0x8800
    s_mov_b32 s9, 0x280
    buffer_load_dwordx4 v207, s[16:19], s9 offen sc1 lds
    s_add_u32 m0, s64, 0x8800
    s_mov_b32 s9, 0x280
    buffer_load_dwordx4 v208, s[16:19], s9 offen sc1 lds
    s_add_u32 m0, s56, 0x8800
    s_mov_b32 s9, 0xf0000
    buffer_load_dwordx4 v200, s[20:23], s9 offen lds
    s_add_u32 m0, s57, 0x8800
    s_mov_b32 s9, 0xf0000
    buffer_load_dwordx4 v201, s[20:23], s9 offen lds
    s_add_u32 m0, s58, 0x8800
    s_mov_b32 s9, 0xf0000
    buffer_load_dwordx4 v202, s[20:23], s9 offen lds
    s_add_u32 m0, s59, 0x8800
    s_mov_b32 s9, 0xf0000
    buffer_load_dwordx4 v203, s[20:23], s9 offen lds
    s_add_u32 m0, s60, 0x8800
    s_mov_b32 s9, 0xf0000
    buffer_load_dwordx4 v204, s[20:23], s9 offen lds
    s_add_u32 m0, s61, 0x8800
    s_mov_b32 s9, 0xf0000
    buffer_load_dwordx4 v205, s[20:23], s9 offen lds
    s_cmp_eq_u32 s66, 3
    s_cbranch_scc1 nost_30
    ds_read_b128 v[32:35], v2
    ds_read_b128 v[36:39], v3
    ds_read_b128 v[40:43], v4
    ds_read_b128 v[44:47], v5
    v_add_u32 v2, 0x8800, v2
    v_add_u32 v3, 0x8800, v3
    v_add_u32 v4, 0x8800, v4
    v_add_u32 v5, 0x8800, v5
    s_waitcnt lgkmcnt(3)
    v_dot2_f32_bf16 v12, v32, s15, v12
    v_dot2_f32_bf16 v14, v32, v32, v14
    v_dot2_f32_bf16 v13, v33, s15, v13
    v_dot2_f32_bf16 v15, v33, v33, v15
    v_dot2_f32_bf16 v12, v34, s15, v12
    v_dot2_f32_bf16 v14, v34, v34, v14
    v_dot2_f32_bf16 v13, v35, s15, v13
    v_dot2_f32_bf16 v15, v35, v35, v15
    s_waitcnt lgkmcnt(2)
    v_dot2_f32_bf16 v12, v36, s15, v12
    v_dot2_f32_bf16 v14, v36, v36, v14
    v_dot2_f32_bf16 v13, v37, s15, v13
    v_dot2_f32_bf16 v15, v37, v37, v15
    v_dot2_f32_bf16 v12, v38, s15, v12
    v_dot2_f32_bf16 v14, v38, v38, v14
    v_dot2_f32_bf16 v13, v39, s15, v13
    v_dot2_f32_bf16 v15, v39, v39, v15
    s_waitcnt lgkmcnt(1)
    v_dot2_f32_bf16 v12, v40, s15, v12
    v_dot2_f32_bf16 v14, v40, v40, v14
    v_dot2_f32_bf16 v13, v41, s15, v13
    v_dot2_f32_bf16 v15, v41, v41, v15
    v_dot2_f32_bf16 v12, v42, s15, v12
    v_dot2_f32_bf16 v14, v42, v42, v14
    v_dot2_f32_bf16 v13, v43, s15, v13
    v_dot2_f32_bf16 v15, v43, v43, v15
    s_waitcnt lgkmcnt(0)
    v_dot2_f32_bf16 v12, v44, s15, v12
    v_dot2_f32_bf16 v14, v44, v44, v14
    v_dot2_f32_bf16 v13, v45, s15, v13
    v_dot2_f32_bf16 v15, v45, v45, v15
    v_dot2_f32_bf16 v12, v46, s15, v12
    v_dot2_f32_bf16 v14, v46, v46, v14
    v_dot2_f32_bf16 v13, v47, s15, v13
    v_dot2_f32_bf16 v15, v47, v47, v15
nost_30:
    s_waitcnt vmcnt(19)
    s_barrier
    s_add_u32 m0, s62, 0x11000
    s_mov_b32 s9, 0x300
    buffer_load_dwordx4 v206, s[16:19], s9 offen sc1 lds
    s_add_u32 m0, s63, 0x11000
    s_mov_b32 s9, 0x300
    buffer_load_dwordx4 v207, s[16:19], s9 offen sc1 lds
    s_add_u32 m0, s64, 0x11000
    s_mov_b32 s9, 0x300
    buffer_load_dwordx4 v208, s[16:19], s9 offen sc1 lds
    s_add_u32 m0, s56, 0x11000
    s_mov_b32 s9, 0x120000
    buffer_load_dwordx4 v200, s[20:23], s9 offen lds
    s_add_u32 m0, s57, 0x11000
    s_mov_b32 s9, 0x120000
    buffer_load_dwordx4 v201, s[20:23], s9 offen lds
    s_add_u32 m0, s58, 0x11000
    s_mov_b32 s9, 0x120000
    buffer_load_dwordx4 v202, s[20:23], s9 offen lds
    s_add_u32 m0, s59, 0x11000
    s_mov_b32 s9, 0x120000
    buffer_load_dwordx4 v203, s[20:23], s9 offen lds
    s_add_u32 m0, s60, 0x11000
    s_mov_b32 s9, 0x120000
    buffer_load_dwordx4 v204, s[20:23], s9 offen lds
    s_add_u32 m0, s61, 0x11000
    s_mov_b32 s9, 0x120000
    buffer_load_dwordx4 v205, s[20:23], s9 offen lds
    s_cmp_eq_u32 s66, 3
    s_cbranch_scc1 nost_31
    ds_read_b128 v[32:35], v2
    ds_read_b128 v[36:39], v3
    ds_read_b128 v[40:43], v4
    ds_read_b128 v[44:47], v5
    v_add_u32 v2, 0xfffe6800, v2
    v_add_u32 v3, 0xfffe6800, v3
    v_add_u32 v4, 0xfffe6800, v4
    v_add_u32 v5, 0xfffe6800, v5
    s_waitcnt lgkmcnt(3)
    v_dot2_f32_bf16 v12, v32, s15, v12
    v_dot2_f32_bf16 v14, v32, v32, v14
    v_dot2_f32_bf16 v13, v33, s15, v13
    v_dot2_f32_bf16 v15, v33, v33, v15
    v_dot2_f32_bf16 v12, v34, s15, v12
    v_dot2_f32_bf16 v14, v34, v34, v14
    v_dot2_f32_bf16 v13, v35, s15, v13
    v_dot2_f32_bf16 v15, v35, v35, v15
    s_waitcnt lgkmcnt(2)
    v_dot2_f32_bf16 v12, v36, s15, v12
    v_dot2_f32_bf16 v14, v36, v36, v14
    v_dot2_f32_bf16 v13, v37, s15, v13
    v_dot2_f32_bf16 v15, v37, v37, v15
    v_dot2_f32_bf16 v12, v38, s15, v12
    v_dot2_f32_bf16 v14, v38, v38, v14
    v_dot2_f32_bf16 v13, v39, s15, v13
    v_dot2_f32_bf16 v15, v39, v39, v15
    s_waitcnt lgkmcnt(1)
    v_dot2_f32_bf16 v12, v40, s15, v12
    v_dot2_f32_bf16 v14, v40, v40, v14
    v_dot2_f32_bf16 v13, v41, s15, v13
    v_dot2_f32_bf16 v15, v41, v41, v15
    v_dot2_f32_bf16 v12, v42, s15, v12
    v_dot2_f32_bf16 v14, v42, v42, v14
    v_dot2_f32_bf16 v13, v43, s15, v13
    v_dot2_f32_bf16 v15, v43, v43, v15
    s_waitcnt lgkmcnt(0)
    v_dot2_f32_bf16 v12, v44, s15, v12
    v_dot2_f32_bf16 v14, v44, v44, v14
    v_dot2_f32_bf16 v13, v45, s15, v13
    v_dot2_f32_bf16 v15, v45, v45, v15
    v_dot2_f32_bf16 v12, v46, s15, v12
    v_dot2_f32_bf16 v14, v46, v46, v14
    v_dot2_f32_bf16 v13, v47, s15, v13
    v_dot2_f32_bf16 v15, v47, v47, v15
nost_31:
    s_waitcnt vmcnt(19)
    s_barrier
    s_add_u32 m0, s62, 0x19800
    s_mov_b32 s9, 0x380
    buffer_load_dwordx4 v206, s[16:19], s9 offen sc1 lds
    s_add_u32 m0, s63, 0x19800
    s_mov_b32 s9, 0x380
    buffer_load_dwordx4 v207, s[16:19], s9 offen sc1 lds
    s_add_u32 m0, s64, 0x19800
    s_mov_b32 s9, 0x380
    buffer_load_dwordx4 v208, s[16:19], s9 offen sc1 lds
    s_add_u32 m0, s56, 0x19800
    s_mov_b32 s9, 0x150000
    buffer_load_dwordx4 v200, s[20:23], s9 offen lds
    s_add_u32 m0, s57, 0x19800
    s_mov_b32 s9, 0x150000
    buffer_load_dwordx4 v201, s[20:23], s9 offen lds
    s_add_u32 m0, s58, 0x19800
    s_mov_b32 s9, 0x150000
    buffer_load_dwordx4 v202, s[20:23], s9 offen lds
    s_add_u32 m0, s59, 0x19800
    s_mov_b32 s9, 0x150000
    buffer_load_dwordx4 v203, s[20:23], s9 offen lds
    s_add_u32 m0, s60, 0x19800
    s_mov_b32 s9, 0x150000
    buffer_load_dwordx4 v204, s[20:23], s9 offen lds
    s_add_u32 m0, s61, 0x19800
    s_mov_b32 s9, 0x150000
    buffer_load_dwordx4 v205, s[20:23], s9 offen lds
    s_cmp_eq_u32 s66, 3
    s_cbranch_scc1 nost_32
    ds_read_b128 v[32:35], v2
    ds_read_b128 v[36:39], v3
    ds_read_b128 v[40:43], v4
    ds_read_b128 v[44:47], v5
    v_add_u32 v2, 0x8800, v2
    v_add_u32 v3, 0x8800, v3
    v_add_u32 v4, 0x8800, v4
    v_add_u32 v5, 0x8800, v5
    s_waitcnt lgkmcnt(3)
    v_dot2_f32_bf16 v12, v32, s15, v12
    v_dot2_f32_bf16 v14, v32, v32, v14
    v_dot2_f32_bf16 v13, v33, s15, v13
    v_dot2_f32_bf16 v15, v33, v33, v15
    v_dot2_f32_bf16 v12, v34, s15, v12
    v_dot2_f32_bf16 v14, v34, v34, v14
    v_dot2_f32_bf16 v13, v35, s15, v13
    v_dot2_f32_bf16 v15, v35, v35, v15
    s_waitcnt lgkmcnt(2)
    v_dot2_f32_bf16 v12, v36, s15, v12
    v_dot2_f32_bf16 v14, v36, v36, v14
    v_dot2_f32_bf16 v13, v37, s15, v13
    v_dot2_f32_bf16 v15, v37, v37, v15
    v_dot2_f32_bf16 v12, v38, s15, v12
    v_dot2_f32_bf16 v14, v38, v38, v14
    v_dot2_f32_bf16 v13, v39, s15, v13
    v_dot2_f32_bf16 v15, v39, v39, v15
    s_waitcnt lgkmcnt(1)
    v_dot2_f32_bf16 v12, v40, s15, v12
    v_dot2_f32_bf16 v14, v40, v40, v14
    v_dot2_f32_bf16 v13, v41, s15, v13
    v_dot2_f32_bf16 v15, v41, v41, v15
    v_dot2_f32_bf16 v12, v42, s15, v12
    v_dot2_f32_bf16 v14, v42, v42, v14
    v_dot2_f32_bf16 v13, v43, s15, v13
    v_dot2_f32_bf16 v15, v43, v43, v15
    s_waitcnt lgkmcnt(0)
    v_dot2_f32_bf16 v12, v44, s15, v12
    v_dot2_f32_bf16 v14, v44, v44, v14
    v_dot2_f32_bf16 v13, v45, s15, v13
    v_dot2_f32_bf16 v15, v45, v45, v15
    v_dot2_f32_bf16 v12, v46, s15, v12
    v_dot2_f32_bf16 v14, v46, v46, v14
    v_dot2_f32_bf16 v13, v47, s15, v13
    v_dot2_f32_bf16 v15, v47, v47, v15
nost_32:
    s_waitcnt vmcnt(18)
    s_barrier
    s_mov_b32 s32, s52
    s_mov_b32 s33, s53
    s_mov_b32 s34, 0x1000000
    s_mov_b32 s35, 0x20000
    s_lshl_b32 s6, s10, 16
    s_lshl_b32 s7, s11, 12
    s_add_u32 s6, s6, s7
    s_and_b32 s7, s66, 1
    s_lshl_b32 s7, s7, 15
    s_add_u32 s6, s6, s7
    s_lshr_b32 s7, s66, 1
    s_lshl_b32 s7, s7, 21
    s_add_u32 s6, s6, s7
    v_and_b32 v211, 31, v1
    v_lshl_add_u32 v211, v211, 7, s6
    buffer_load_dword v242, v211, s[32:35], 0 offen sc1
    s_lshl_b32 s6, s10, 12
    s_lshl_b32 s7, s11, 8
    s_add_u32 s6, s6, s7
    s_add_u32 s6, s6, 14680064
    v_and_b32 v211, 1, v1
    v_lshl_add_u32 v211, v211, 7, s6
    v_bfe_u32 v212, v1, 1, 1
    v_lshl_add_u32 v211, v212, 11, v211
    buffer_load_dword v242, v211, s[32:35], 0 offen sc1
    s_lshl_b32 s6, s4, 7
    v_and_b32 v211, 7, v1
    v_lshl_add_u32 v211, v211, 10, s6
    buffer_load_dword v242, v211, s[96:99], 0 offen sc1
    s_mov_b32 s32, s40
    s_mov_b32 s33, s41
    s_mov_b32 s34, 0x80000
    s_mov_b32 s35, 0x20000
    s_mul_i32 s6, s5, 16384
    s_mul_i32 s7, s66, 4096
    s_add_u32 s6, s6, s7
    v_min_u32 v211, 31, v1
    v_lshl_add_u32 v211, v211, 7, s6
    buffer_load_dword v240, v211, s[32:35], 0 offen
    s_cmp_eq_u32 s66, 3
    s_cbranch_scc1 nost_33
    ds_read_b128 v[32:35], v2
    ds_read_b128 v[36:39], v3
    ds_read_b128 v[40:43], v4
    ds_read_b128 v[44:47], v5
    v_add_u32 v2, 0x8800, v2
    v_add_u32 v3, 0x8800, v3
    v_add_u32 v4, 0x8800, v4
    v_add_u32 v5, 0x8800, v5
    s_waitcnt lgkmcnt(3)
    v_dot2_f32_bf16 v12, v32, s15, v12
    v_dot2_f32_bf16 v14, v32, v32, v14
    v_dot2_f32_bf16 v13, v33, s15, v13
    v_dot2_f32_bf16 v15, v33, v33, v15
    v_dot2_f32_bf16 v12, v34, s15, v12
    v_dot2_f32_bf16 v14, v34, v34, v14
    v_dot2_f32_bf16 v13, v35, s15, v13
    v_dot2_f32_bf16 v15, v35, v35, v15
    s_waitcnt lgkmcnt(2)
    v_dot2_f32_bf16 v12, v36, s15, v12
    v_dot2_f32_bf16 v14, v36, v36, v14
    v_dot2_f32_bf16 v13, v37, s15, v13
    v_dot2_f32_bf16 v15, v37, v37, v15
    v_dot2_f32_bf16 v12, v38, s15, v12
    v_dot2_f32_bf16 v14, v38, v38, v14
    v_dot2_f32_bf16 v13, v39, s15, v13
    v_dot2_f32_bf16 v15, v39, v39, v15
    s_waitcnt lgkmcnt(1)
    v_dot2_f32_bf16 v12, v40, s15, v12
    v_dot2_f32_bf16 v14, v40, v40, v14
    v_dot2_f32_bf16 v13, v41, s15, v13
    v_dot2_f32_bf16 v15, v41, v41, v15
    v_dot2_f32_bf16 v12, v42, s15, v12
    v_dot2_f32_bf16 v14, v42, v42, v14
    v_dot2_f32_bf16 v13, v43, s15, v13
    v_dot2_f32_bf16 v15, v43, v43, v15
    s_waitcnt lgkmcnt(0)
    v_dot2_f32_bf16 v12, v44, s15, v12
    v_dot2_f32_bf16 v14, v44, v44, v14
    v_dot2_f32_bf16 v13, v45, s15, v13
    v_dot2_f32_bf16 v15, v45, v45, v15
    v_dot2_f32_bf16 v12, v46, s15, v12
    v_dot2_f32_bf16 v14, v46, v46, v14
    v_dot2_f32_bf16 v13, v47, s15, v13
    v_dot2_f32_bf16 v15, v47, v47, v15
nost_33:
    s_waitcnt vmcnt(4)
    s_barrier
    s_setprio 2
    s_cmp_eq_u32 s66, 3
    s_cbranch_scc1 nost_34
    ds_read_b128 v[32:35], v2
    ds_read_b128 v[36:39], v3
    ds_read_b128 v[40:43], v4
    ds_read_b128 v[44:47], v5
    v_add_u32 v2, 0x8800, v2
    v_add_u32 v3, 0x8800, v3
    v_add_u32 v4, 0x8800, v4
    v_add_u32 v5, 0x8800, v5
    s_waitcnt lgkmcnt(3)
    v_dot2_f32_bf16 v12, v32, s15, v12
    v_dot2_f32_bf16 v14, v32, v32, v14
    v_dot2_f32_bf16 v13, v33, s15, v13
    v_dot2_f32_bf16 v15, v33, v33, v15
    v_dot2_f32_bf16 v12, v34, s15, v12
    v_dot2_f32_bf16 v14, v34, v34, v14
    v_dot2_f32_bf16 v13, v35, s15, v13
    v_dot2_f32_bf16 v15, v35, v35, v15
    s_waitcnt lgkmcnt(2)
    v_dot2_f32_bf16 v12, v36, s15, v12
    v_dot2_f32_bf16 v14, v36, v36, v14
    v_dot2_f32_bf16 v13, v37, s15, v13
    v_dot2_f32_bf16 v15, v37, v37, v15
    v_dot2_f32_bf16 v12, v38, s15, v12
    v_dot2_f32_bf16 v14, v38, v38, v14
    v_dot2_f32_bf16 v13, v39, s15, v13
    v_dot2_f32_bf16 v15, v39, v39, v15
    s_waitcnt lgkmcnt(1)
    v_dot2_f32_bf16 v12, v40, s15, v12
    v_dot2_f32_bf16 v14, v40, v40, v14
    v_dot2_f32_bf16 v13, v41, s15, v13
    v_dot2_f32_bf16 v15, v41, v41, v15
    v_dot2_f32_bf16 v12, v42, s15, v12
    v_dot2_f32_bf16 v14, v42, v42, v14
    v_dot2_f32_bf16 v13, v43, s15, v13
    v_dot2_f32_bf16 v15, v43, v43, v15
    s_waitcnt lgkmcnt(0)
    v_dot2_f32_bf16 v12, v44, s15, v12
    v_dot2_f32_bf16 v14, v44, v44, v14
    v_dot2_f32_bf16 v13, v45, s15, v13
    v_dot2_f32_bf16 v15, v45, v45, v15
    v_dot2_f32_bf16 v12, v46, s15, v12
    v_dot2_f32_bf16 v14, v46, v46, v14
    v_dot2_f32_bf16 v13, v47, s15, v13
    v_dot2_f32_bf16 v15, v47, v47, v15
nost_34:
    s_cmp_eq_u32 s66, 3
    s_cbranch_scc1 nost_35
    ds_read_b128 v[32:35], v2
    ds_read_b128 v[36:39], v3
    ds_read_b128 v[40:43], v4
    ds_read_b128 v[44:47], v5
    s_waitcnt lgkmcnt(3)
    v_dot2_f32_bf16 v12, v32, s15, v12
    v_dot2_f32_bf16 v14, v32, v32, v14
    v_dot2_f32_bf16 v13, v33, s15, v13
    v_dot2_f32_bf16 v15, v33, v33, v15
    v_dot2_f32_bf16 v12, v34, s15, v12
    v_dot2_f32_bf16 v14, v34, v34, v14
    v_dot2_f32_bf16 v13, v35, s15, v13
    v_dot2_f32_bf16 v15, v35, v35, v15
    s_waitcnt lgkmcnt(2)
    v_dot2_f32_bf16 v12, v36, s15, v12
    v_dot2_f32_bf16 v14, v36, v36, v14
    v_dot2_f32_bf16 v13, v37, s15, v13
    v_dot2_f32_bf16 v15, v37, v37, v15
    v_dot2_f32_bf16 v12, v38, s15, v12
    v_dot2_f32_bf16 v14, v38, v38, v14
    v_dot2_f32_bf16 v13, v39, s15, v13
    v_dot2_f32_bf16 v15, v39, v39, v15
    s_waitcnt lgkmcnt(1)
    v_dot2_f32_bf16 v12, v40, s15, v12
    v_dot2_f32_bf16 v14, v40, v40, v14
    v_dot2_f32_bf16 v13, v41, s15, v13
    v_dot2_f32_bf16 v15, v41, v41, v15
    v_dot2_f32_bf16 v12, v42, s15, v12
    v_dot2_f32_bf16 v14, v42, v42, v14
    v_dot2_f32_bf16 v13, v43, s15, v13
    v_dot2_f32_bf16 v15, v43, v43, v15
    s_waitcnt lgkmcnt(0)
    v_dot2_f32_bf16 v12, v44, s15, v12
    v_dot2_f32_bf16 v14, v44, v44, v14
    v_dot2_f32_bf16 v13, v45, s15, v13
    v_dot2_f32_bf16 v15, v45, v45, v15
    v_dot2_f32_bf16 v12, v46, s15, v12
    v_dot2_f32_bf16 v14, v46, v46, v14
    v_dot2_f32_bf16 v13, v47, s15, v13
    v_dot2_f32_bf16 v15, v47, v47, v15
nost_35:
    s_nop 2
    v_add_f32 v12, v12, v13
    v_add_f32 v13, v14, v15
    v_mov_b32 v14, v12
    s_nop 1
    v_permlane32_swap_b32 v14, v12
    s_nop 0
    v_add_f32 v12, v12, v14
    v_mov_b32 v14, v13
    s_nop 1
    v_permlane32_swap_b32 v14, v13
    s_nop 0
    v_add_f32 v13, v13, v14
    v_mul_f32 v12, 0x3b000000, v12
    v_mul_f32 v13, 0x3b000000, v13
    v_fma_f32 v13, -v12, v12, v13
    v_max_f32 v13, 0, v13
    v_add_f32 v13, 0x3727c5ac, v13
    v_rsq_f32 v13, v13
    s_nop 0
    v_sub_f32 v12, 0, v12
    s_cmp_eq_u32 s66, 3
    s_cbranch_scc1 nosw_36
    ds_write_b64 v6, v[12:13]
nosw_36:
    s_mov_b32 s32, s44
    s_mov_b32 s33, s45
    s_mov_b32 s34, 0x1c0000
    s_mov_b32 s35, 0x20000
    s_mov_b32 s6, 0
    s_mul_i32 s7, s5, 32768
    s_add_u32 s6, s6, s7
    s_mul_i32 s7, s66, 8192
    s_add_u32 s6, s6, s7
    v_min_u32 v211, 63, v1
    v_lshl_add_u32 v211, v211, 7, s6
    buffer_load_dword v240, v211, s[32:35], 0 offen
    s_waitcnt lgkmcnt(0)
    s_barrier
p1att_4:
    s_setprio 0
    s_lshr_b32 s56, s3, 2
    s_and_b32 s57, s3, 3
    v_and_b32 v9, 31, v1
    s_lshl_b32 s6, s56, 5
    v_add_u32 v9, s6, v9
    v_lshrrev_b32 v10, 5, v1
    s_lshl_b32 s6, s57, 5
    v_mul_u32_u24 v2, 144, v9
    v_add_u32 v2, s6, v2
    v_lshl_add_u32 v2, v10, 4, v2
    s_lshl_b32 s6, s57, 6
    v_mul_u32_u24 v3, 272, v9
    v_lshl_add_u32 v3, v10, 5, v3
    v_add_u32 v3, s6, v3
    s_lshl_b32 s6, s10, 6
    v_add_u32 v4, s6, v9
    s_lshl_b32 s6, s10, 1
    s_add_u32 s6, s6, s56
    s_lshl_b32 s6, s6, 5
    s_lshl_b32 s7, s11, 2
    s_add_u32 s6, s6, s7
    s_add_u32 s6, s6, s57
    s_lshl_b32 s6, s6, 10
    v_lshl_add_u32 v5, v1, 4, s6
    s_mov_b32 s20, s40
    s_mov_b32 s21, s41
    s_mov_b32 s22, 0x80000
    s_mov_b32 s23, 0x20000
    v_lshrrev_b32 v9, 3, v1
    s_mov_b32 s6, 1024
    v_mul_lo_u32 v14, v9, s6
    v_bfe_u32 v9, v1, 4, 1
    v_lshlrev_b32 v9, 2, v9
    v_lshl_or_b32 v9, s13, 1, v9
    v_and_b32 v10, 7, v1
    v_xor_b32 v9, v9, v10
    v_lshl_add_u32 v14, v9, 4, v14
    s_mul_i32 s6, s12, 131072
    s_and_b32 s7, s5, 7
    s_lshl_b32 s7, s7, 7
    s_add_u32 s6, s6, s7
    s_mul_i32 s14, s12, 16384
    s_add_u32 s14, s14, 98304
    s_lshl_b32 s7, s13, 13
    s_add_u32 s6, s6, s7
    s_lshl_b32 s7, s13, 10
    s_add_u32 s14, s14, s7
    v_add_u32 v14, s6, v14
    v_mov_b32 v6, 0xce6e6b28
    v_mov_b32 v7, 0x3eb8aa3b
    s_waitcnt lgkmcnt(0)
    s_barrier
    ds_read_b128 v[16:19], v2 offset:0
    ds_read_b128 v[32:35], v2 offset:11520
    ds_read_b128 v[36:39], v2 offset:11232
    ds_read_b128 v[40:43], v2 offset:10944
    ds_read_b128 v[44:47], v2 offset:10656
    ds_read_b128 v[48:51], v2 offset:10368
    ds_read_b128 v[52:55], v2 offset:10080
    ds_read_b128 v[56:59], v2 offset:9792
    ds_read_b128 v[60:63], v2 offset:9504
    ds_read_b128 v[96:99], v3 offset:25088
    ds_read_b128 v[100:103], v3 offset:25104
    s_add_u32 m0, s14, 0x0
    s_nop 0
    buffer_load_dwordx4 v14, s[20:23], 0 offen lds
    ds_read_b128 v[104:107], v3 offset:24544
    ds_read_b128 v[108:111], v3 offset:24560
    s_waitcnt lgkmcnt(10)
    v_dot2_f32_bf16 v160, v16, v32, 0
    v_dot2_f32_bf16 v161, v16, v36, 0
    v_dot2_f32_bf16 v160, v17, v33, v160
    v_dot2_f32_bf16 v161, v17, v37, v161
    v_dot2_f32_bf16 v160, v18, v34, v160
    v_dot2_f32_bf16 v161, v18, v38, v161
    v_dot2_f32_bf16 v160, v19, v35, v160
    v_dot2_f32_bf16 v161, v19, v39, v161
    s_add_u32 m0, s14, 0x800
    s_mov_b32 s9, 0x4000
    buffer_load_dwordx4 v14, s[20:23], s9 offen lds
    ds_read_b128 v[112:115], v3 offset:24000
    ds_read_b128 v[116:119], v3 offset:24016
    s_add_u32 m0, s14, 0x1000
    s_mov_b32 s9, 0x8000
    buffer_load_dwordx4 v14, s[20:23], s9 offen lds
    ds_read_b128 v[120:123], v3 offset:23456
    ds_read_b128 v[124:127], v3 offset:23472
    s_waitcnt lgkmcnt(12)
    v_dot2_f32_bf16 v162, v16, v40, 0
    v_dot2_f32_bf16 v163, v16, v44, 0
    v_dot2_f32_bf16 v162, v17, v41, v162
    v_dot2_f32_bf16 v163, v17, v45, v163
    v_dot2_f32_bf16 v162, v18, v42, v162
    v_dot2_f32_bf16 v163, v18, v46, v163
    v_dot2_f32_bf16 v162, v19, v43, v162
    v_dot2_f32_bf16 v163, v19, v47, v163
    s_add_u32 m0, s14, 0x1800
    s_mov_b32 s9, 0xc000
    buffer_load_dwordx4 v14, s[20:23], s9 offen lds
    ds_read_b128 v[128:131], v3 offset:22912
    ds_read_b128 v[132:135], v3 offset:22928
    s_add_u32 m0, s14, 0x2000
    s_mov_b32 s9, 0x10000
    buffer_load_dwordx4 v14, s[20:23], s9 offen lds
    ds_read_b128 v[136:139], v3 offset:22368
    ds_read_b128 v[140:143], v3 offset:22384
    s_waitcnt lgkmcnt(14)
    v_dot2_f32_bf16 v164, v16, v48, 0
    v_dot2_f32_bf16 v165, v16, v52, 0
    v_dot2_f32_bf16 v164, v17, v49, v164
    v_dot2_f32_bf16 v165, v17, v53, v165
    v_dot2_f32_bf16 v164, v18, v50, v164
    v_dot2_f32_bf16 v165, v18, v54, v165
    v_dot2_f32_bf16 v164, v19, v51, v164
    v_dot2_f32_bf16 v165, v19, v55, v165
    s_add_u32 m0, s14, 0x2800
    s_mov_b32 s9, 0x14000
    buffer_load_dwordx4 v14, s[20:23], s9 offen lds
    ds_read_b128 v[144:147], v3 offset:21824
    ds_read_b128 v[148:151], v3 offset:21840
    s_add_u32 m0, s14, 0x3000
    s_mov_b32 s9, 0x18000
    buffer_load_dwordx4 v14, s[20:23], s9 offen lds
    ds_read_b128 v[152:155], v3 offset:21280
    ds_read_b128 v[156:159], v3 offset:21296
    s_waitcnt lgkmcnt(15)
    v_dot2_f32_bf16 v166, v16, v56, 0
    v_dot2_f32_bf16 v167, v16, v60, 0
    v_dot2_f32_bf16 v166, v17, v57, v166
    v_dot2_f32_bf16 v167, v17, v61, v167
    v_dot2_f32_bf16 v166, v18, v58, v166
    v_dot2_f32_bf16 v167, v18, v62, v167
    v_dot2_f32_bf16 v166, v19, v59, v166
    v_dot2_f32_bf16 v167, v19, v63, v167
    s_add_u32 m0, s14, 0x3800
    s_mov_b32 s9, 0x1c000
    buffer_load_dwordx4 v14, s[20:23], s9 offen lds
    v_mov_b32 v32, v160
    v_mov_b32 v33, v161
    v_mov_b32 v34, v162
    v_mov_b32 v35, v163
    v_mov_b32 v36, v164
    v_mov_b32 v37, v165
    v_mov_b32 v38, v166
    v_mov_b32 v39, v167
    v_permlane32_swap_b32 v32, v160
    v_permlane32_swap_b32 v33, v161
    v_permlane32_swap_b32 v34, v162
    v_permlane32_swap_b32 v35, v163
    v_permlane32_swap_b32 v36, v164
    v_permlane32_swap_b32 v37, v165
    v_permlane32_swap_b32 v38, v166
    v_permlane32_swap_b32 v39, v167
    v_pk_add_f32 v[160:161], v[160:161], v[32:33]
    v_pk_add_f32 v[162:163], v[162:163], v[34:35]
    v_pk_add_f32 v[164:165], v[164:165], v[36:37]
    v_pk_add_f32 v[166:167], v[166:167], v[38:39]
    v_cmp_le_u32 s[58:59], 2, v4
    v_cmp_le_u32 s[60:61], 4, v4
    v_cmp_le_u32 s[62:63], 6, v4
    v_cmp_le_u32 s[64:65], 8, v4
    v_cmp_le_u32 s[66:67], 10, v4
    v_cmp_le_u32 s[68:69], 12, v4
    v_cmp_le_u32 s[70:71], 14, v4
    v_cndmask_b32 v161, v6, v161, s[58:59]
    v_cndmask_b32 v162, v6, v162, s[60:61]
    v_cndmask_b32 v163, v6, v163, s[62:63]
    v_cndmask_b32 v164, v6, v164, s[64:65]
    v_cndmask_b32 v165, v6, v165, s[66:67]
    v_cndmask_b32 v166, v6, v166, s[68:69]
    v_cndmask_b32 v167, v6, v167, s[70:71]
    v_max3_f32 v8, v160, v161, v162
    v_max3_f32 v8, v8, v163, v164
    v_max3_f32 v8, v8, v165, v166
    v_max_f32 v8, v8, v167
    v_sub_f32 v160, v160, v8
    v_sub_f32 v161, v161, v8
    v_sub_f32 v162, v162, v8
    v_sub_f32 v163, v163, v8
    v_sub_f32 v164, v164, v8
    v_sub_f32 v165, v165, v8
    v_sub_f32 v166, v166, v8
    v_sub_f32 v167, v167, v8
    v_mul_f32 v160, v7, v160
    v_mul_f32 v161, v7, v161
    v_mul_f32 v162, v7, v162
    v_mul_f32 v163, v7, v163
    v_mul_f32 v164, v7, v164
    v_mul_f32 v165, v7, v165
    v_mul_f32 v166, v7, v166
    v_mul_f32 v167, v7, v167
    v_exp_f32 v160, v160
    v_exp_f32 v161, v161
    v_exp_f32 v162, v162
    v_exp_f32 v163, v163
    v_exp_f32 v164, v164
    v_exp_f32 v165, v165
    v_exp_f32 v166, v166
    v_exp_f32 v167, v167
    s_nop 0
    v_pk_add_f32 v[10:11], v[160:161], v[162:163]
    v_pk_add_f32 v[12:13], v[164:165], v[166:167]
    v_pk_add_f32 v[10:11], v[10:11], v[12:13]
    v_add_f32 v10, v10, v11
    v_rcp_f32 v10, v10
    s_waitcnt lgkmcnt(14)
    v_pk_mul_f32 v[176:177], v[96:97], v[160:161] op_sel_hi:[1,0]
    v_pk_mul_f32 v[178:179], v[98:99], v[160:161] op_sel_hi:[1,0]
    v_pk_mul_f32 v[180:181], v[100:101], v[160:161] op_sel_hi:[1,0]
    v_pk_mul_f32 v[182:183], v[102:103], v[160:161] op_sel_hi:[1,0]
    s_waitcnt lgkmcnt(12)
    v_pk_fma_f32 v[176:177], v[104:105], v[160:161], v[176:177] op_sel:[0,1,0] op_sel_hi:[1,1,1]
    v_pk_fma_f32 v[178:179], v[106:107], v[160:161], v[178:179] op_sel:[0,1,0] op_sel_hi:[1,1,1]
    v_pk_fma_f32 v[180:181], v[108:109], v[160:161], v[180:181] op_sel:[0,1,0] op_sel_hi:[1,1,1]
    v_pk_fma_f32 v[182:183], v[110:111], v[160:161], v[182:183] op_sel:[0,1,0] op_sel_hi:[1,1,1]
    s_waitcnt lgkmcnt(10)
    v_pk_fma_f32 v[176:177], v[112:113], v[162:163], v[176:177] op_sel:[0,0,0] op_sel_hi:[1,0,1]
    v_pk_fma_f32 v[178:179], v[114:115], v[162:163], v[178:179] op_sel:[0,0,0] op_sel_hi:[1,0,1]
    v_pk_fma_f32 v[180:181], v[116:117], v[162:163], v[180:181] op_sel:[0,0,0] op_sel_hi:[1,0,1]
    v_pk_fma_f32 v[182:183], v[118:119], v[162:163], v[182:183] op_sel:[0,0,0] op_sel_hi:[1,0,1]
    s_waitcnt lgkmcnt(8)
    v_pk_fma_f32 v[176:177], v[120:121], v[162:163], v[176:177] op_sel:[0,1,0] op_sel_hi:[1,1,1]
    v_pk_fma_f32 v[178:179], v[122:123], v[162:163], v[178:179] op_sel:[0,1,0] op_sel_hi:[1,1,1]
    v_pk_fma_f32 v[180:181], v[124:125], v[162:163], v[180:181] op_sel:[0,1,0] op_sel_hi:[1,1,1]
    v_pk_fma_f32 v[182:183], v[126:127], v[162:163], v[182:183] op_sel:[0,1,0] op_sel_hi:[1,1,1]
    s_waitcnt lgkmcnt(6)
    v_pk_fma_f32 v[176:177], v[128:129], v[164:165], v[176:177] op_sel:[0,0,0] op_sel_hi:[1,0,1]
    v_pk_fma_f32 v[178:179], v[130:131], v[164:165], v[178:179] op_sel:[0,0,0] op_sel_hi:[1,0,1]
    v_pk_fma_f32 v[180:181], v[132:133], v[164:165], v[180:181] op_sel:[0,0,0] op_sel_hi:[1,0,1]
    v_pk_fma_f32 v[182:183], v[134:135], v[164:165], v[182:183] op_sel:[0,0,0] op_sel_hi:[1,0,1]
    s_waitcnt lgkmcnt(4)
    v_pk_fma_f32 v[176:177], v[136:137], v[164:165], v[176:177] op_sel:[0,1,0] op_sel_hi:[1,1,1]
    v_pk_fma_f32 v[178:179], v[138:139], v[164:165], v[178:179] op_sel:[0,1,0] op_sel_hi:[1,1,1]
    v_pk_fma_f32 v[180:181], v[140:141], v[164:165], v[180:181] op_sel:[0,1,0] op_sel_hi:[1,1,1]
    v_pk_fma_f32 v[182:183], v[142:143], v[164:165], v[182:183] op_sel:[0,1,0] op_sel_hi:[1,1,1]
    s_waitcnt lgkmcnt(2)
    v_pk_fma_f32 v[176:177], v[144:145], v[166:167], v[176:177] op_sel:[0,0,0] op_sel_hi:[1,0,1]
    v_pk_fma_f32 v[178:179], v[146:147], v[166:167], v[178:179] op_sel:[0,0,0] op_sel_hi:[1,0,1]
    v_pk_fma_f32 v[180:181], v[148:149], v[166:167], v[180:181] op_sel:[0,0,0] op_sel_hi:[1,0,1]
    v_pk_fma_f32 v[182:183], v[150:151], v[166:167], v[182:183] op_sel:[0,0,0] op_sel_hi:[1,0,1]
    s_waitcnt lgkmcnt(0)
    v_pk_fma_f32 v[176:177], v[152:153], v[166:167], v[176:177] op_sel:[0,1,0] op_sel_hi:[1,1,1]
    v_pk_fma_f32 v[178:179], v[154:155], v[166:167], v[178:179] op_sel:[0,1,0] op_sel_hi:[1,1,1]
    v_pk_fma_f32 v[180:181], v[156:157], v[166:167], v[180:181] op_sel:[0,1,0] op_sel_hi:[1,1,1]
    v_pk_fma_f32 v[182:183], v[158:159], v[166:167], v[182:183] op_sel:[0,1,0] op_sel_hi:[1,1,1]
    v_pk_mul_f32 v[176:177], v[176:177], v[10:11] op_sel_hi:[1,0]
    v_pk_mul_f32 v[178:179], v[178:179], v[10:11] op_sel_hi:[1,0]
    v_pk_mul_f32 v[180:181], v[180:181], v[10:11] op_sel_hi:[1,0]
    v_pk_mul_f32 v[182:183], v[182:183], v[10:11] op_sel_hi:[1,0]
    v_cvt_pk_bf16_f32 v16, v176, v177
    v_cvt_pk_bf16_f32 v17, v178, v179
    v_cvt_pk_bf16_f32 v18, v180, v181
    v_cvt_pk_bf16_f32 v19, v182, v183
    s_cmp_lg_u32 s100, 0
    s_cbranch_scc1 ifl_37
    s_lshl_b32 s6, s4, 4
    v_mov_b32 v244, s6
    v_mov_b32 v245, 0x80
    s_mov_b32 s9, 0
spin_38:
    buffer_load_dwordx2 v[246:247], v244, s[24:27], 0 offen sc1
    buffer_load_dword v243, v245, s[24:27], 0 offen sc1
    s_waitcnt vmcnt(0)
    v_readfirstlane_b32 s56, v246
    v_readfirstlane_b32 s57, v247
    v_readfirstlane_b32 s55, v243
    s_add_u32 s9, s9, 1
    s_cmp_gt_u32 s9, 0x40000
    s_cbranch_scc1 spun_39
    s_lshr_b32 s6, s57, 24
    s_cmp_lt_u32 s6, 32
    s_cbranch_scc1 spin_38
    s_cmp_eq_u32 s55, 0
    s_cbranch_scc1 spin_38
spun_39:
    s_getreg_b32 s6, hwreg(HW_REG_XCC_ID, 0, 3)
    s_mul_i32 s6, s6, 6
    s_lshr_b64 s[56:57], s[56:57], s6
    s_and_b32 s56, s56, 63
    s_cmp_eq_u32 s56, 32
    s_cselect_b32 s54, 1, 0
ifl_37:
    s_cmp_eq_u32 s54, 0
    s_cbranch_scc1 gs_40
    buffer_store_dwordx4 v[16:19], v5, s[28:31], 0 offen
    s_branch gd_41
gs_40:
    buffer_store_dwordx4 v[16:19], v5, s[28:31], 0 offen sc1
gd_41:
    s_waitcnt vmcnt(0)
    s_barrier
    s_cmp_lg_u32 s3, 0
    s_cbranch_scc1 nopub_42
    s_lshl_b32 s6, s4, 7
    s_lshl_b32 s7, s5, 2
    s_add_u32 s6, s6, s7
    v_mov_b32 v2, s6
    v_mov_b32 v3, s55
    s_mov_b64 exec, 1
    s_add_u32 s8, s101, 0
    s_cmp_eq_u32 s54, 0
    s_cbranch_scc1 gs_43
    buffer_store_dword v3, v2, s[96:99], s8 offen
    s_branch gd_44
gs_43:
    buffer_store_dword v3, v2, s[96:99], s8 offen sc1
gd_44:
    s_mov_b64 exec, -1
nopub_42:
    s_lshr_b32 s10, s5, 3
    s_lshl_b32 s6, s4, 2
    s_add_u32 s10, s10, s6
    s_and_b32 s11, s5, 7
    s_and_b32 s12, s3, 3
    s_lshr_b32 s13, s3, 2
    s_mov_b32 s16, s52
    s_mov_b32 s17, s53
    s_mov_b32 s18, 0x200000
    s_mov_b32 s19, 0x20000
    s_mov_b32 s24, s36
    s_mov_b32 s25, s37
    s_mov_b32 s26, 0x200000
    s_mov_b32 s27, 0x20000
    s_add_u32 s28, s52, 0x200000
    s_addc_u32 s29, s53, 0
    s_mov_b32 s30, 0x200000
    s_mov_b32 s31, 0x20000
    s_add_u32 s32, s52, 0xe00000
    s_addc_u32 s33, s53, 0
    s_mov_b32 s34, 0x20000
    s_mov_b32 s35, 0x20000
    s_lshl_b32 s66, s10, 1
    s_add_u32 s66, s66, s13
    s_mul_i32 s6, s66, 32768
    s_mul_i32 s7, s12, 8192
    s_add_u32 s6, s6, s7
    v_lshl_add_u32 v12, v1, 4, s6
    s_lshl_b32 s6, s66, 5
    s_lshl_b32 s7, s11, 2
    s_add_u32 s7, s7, s12
    s_add_u32 s6, s6, s7
    s_lshl_b32 s6, s6, 10
    v_lshl_add_u32 v4, v1, 4, s6
    s_lshl_b32 s6, s66, 15
    s_lshl_b32 s7, s7, 5
    s_add_u32 s6, s6, s7
    v_and_b32 v9, 31, v1
    v_lshlrev_b32 v9, 10, v9
    v_lshrrev_b32 v10, 5, v1
    v_lshl_add_u32 v9, v10, 4, v9
    v_add_u32 v5, s6, v9
    v_bfe_u32 v9, v1, 2, 2
    v_lshrrev_b32 v10, 5, v1
    v_lshl_add_u32 v6, v10, 3, v9
    v_lshlrev_b32 v6, 7, v6
    v_lshrrev_b32 v9, 1, v9
    v_lshlrev_b32 v9, 2, v9
    v_lshl_or_b32 v9, v10, 1, v9
    v_bfe_u32 v10, v1, 4, 1
    v_and_b32 v11, 1, v1
    v_lshl_or_b32 v10, v10, 1, v11
    v_bfe_u32 v11, v1, 1, 1
    v_xor_b32 v9, v9, v10
    v_lshl_add_u32 v6, v9, 4, v6
    v_lshl_add_u32 v6, v11, 3, v6
    s_mul_i32 s6, s12, 16384
    s_add_u32 s6, s6, 98304
    v_add_u32 v6, s6, v6
    v_xor_b32 v7, 64, v6
    s_mul_i32 s6, s13, 24576
    s_add_u32 s6, s6, 0
    v_lshl_add_u32 v8, v1, 4, s6
    s_cmp_lg_u32 s100, 0
    s_cbranch_scc1 ifl_45
    buffer_load_dwordx4 v[248:251], v5, s[24:27], 0 offen
ifl_45:
    s_and_b32 s58, s5, 24
    s_cmp_lg_u32 s3, 0
    s_cbranch_scc1 nopoll_46
    s_lshl_b32 s6, s4, 7
    s_lshl_b32 s7, s58, 2
    s_add_u32 s6, s6, s7
    s_add_u32 s6, s6, 0
    s_add_u32 s6, s6, s101
    v_min_u32 v2, 7, v1
    v_lshl_add_u32 v2, v2, 2, s6
    s_mov_b32 s9, 0
spin_47:
    buffer_load_dword v3, v2, s[96:99], 0 offen sc1
    s_waitcnt vmcnt(0)
    v_cmp_ne_u32 vcc, s55, v3
    s_add_u32 s9, s9, 1
    s_cmp_gt_u32 s9, 0x40000
    s_cbranch_scc1 spun_48
    s_cbranch_vccnz spin_47
spun_48:
    s_cmp_lg_u32 s54, 0
    s_cbranch_scc1 nopoll_46
    buffer_inv sc1
    s_waitcnt vmcnt(0)
nopoll_46:
    s_barrier
    buffer_load_dwordx4 v[80:83], v12, s[16:19], 0 offen offset:0 sc1
    buffer_load_dwordx4 v[84:87], v12, s[16:19], 0 offen offset:1024 sc1
    buffer_load_dwordx4 v[88:91], v12, s[16:19], 0 offen offset:2048 sc1
    buffer_load_dwordx4 v[92:95], v12, s[16:19], 0 offen offset:3072 sc1
    s_mov_b32 s8, 0x1000
    buffer_load_dwordx4 v[96:99], v12, s[16:19], s8 offen offset:0 sc1
    buffer_load_dwordx4 v[100:103], v12, s[16:19], s8 offen offset:1024 sc1
    buffer_load_dwordx4 v[104:107], v12, s[16:19], s8 offen offset:2048 sc1
    buffer_load_dwordx4 v[108:111], v12, s[16:19], s8 offen offset:3072 sc1
    s_mov_b32 s20, s44
    s_mov_b32 s21, s45
    s_mov_b32 s22, 0x1c0000
    s_mov_b32 s23, 0x20000
    s_mov_b32 s6, 1048576
    s_mul_i32 s7, s5, 24576
    s_add_u32 s6, s6, s7
    s_mul_i32 s7, s3, 3072
    s_add_u32 s6, s6, s7
    v_min_u32 v9, 23, v1
    v_lshl_add_u32 v9, v9, 7, s6
    buffer_load_dword v240, v9, s[20:23], 0 offen
    ds_read_b64_tr_b16 v[48:49], v6 offset:0
    ds_read_b64_tr_b16 v[50:51], v6 offset:512
    ds_read_b64_tr_b16 v[52:53], v7 offset:0
    ds_read_b64_tr_b16 v[54:55], v7 offset:512
    s_waitcnt vmcnt(8)
    ds_read_b64_tr_b16 v[56:57], v6 offset:2048
    ds_read_b64_tr_b16 v[58:59], v6 offset:2560
    s_waitcnt lgkmcnt(4)
    v_mfma_f32_32x32x16_bf16 v[16:31], v[48:51], v[80:83], 0
    ds_read_b64_tr_b16 v[60:61], v7 offset:2048
    ds_read_b64_tr_b16 v[62:63], v7 offset:2560
    s_waitcnt lgkmcnt(4)
    v_mfma_f32_32x32x16_bf16 v[32:47], v[52:55], v[80:83], 0
    s_waitcnt vmcnt(7)
    ds_read_b64_tr_b16 v[48:49], v6 offset:4096
    ds_read_b64_tr_b16 v[50:51], v6 offset:4608
    s_waitcnt lgkmcnt(4)
    v_mfma_f32_32x32x16_bf16 v[16:31], v[56:59], v[84:87], v[16:31]
    ds_read_b64_tr_b16 v[52:53], v7 offset:4096
    ds_read_b64_tr_b16 v[54:55], v7 offset:4608
    s_waitcnt lgkmcnt(4)
    v_mfma_f32_32x32x16_bf16 v[32:47], v[60:63], v[84:87], v[32:47]
    s_waitcnt vmcnt(6)
    ds_read_b64_tr_b16 v[56:57], v6 offset:6144
    ds_read_b64_tr_b16 v[58:59], v6 offset:6656
    s_waitcnt lgkmcnt(4)
    v_mfma_f32_32x32x16_bf16 v[16:31], v[48:51], v[88:91], v[16:31]
    ds_read_b64_tr_b16 v[60:61], v7 offset:6144
    ds_read_b64_tr_b16 v[62:63], v7 offset:6656
    s_waitcnt lgkmcnt(4)
    v_mfma_f32_32x32x16_bf16 v[32:47], v[52:55], v[88:91], v[32:47]
    s_waitcnt vmcnt(5)
    ds_read_b64_tr_b16 v[48:49], v6 offset:8192
    ds_read_b64_tr_b16 v[50:51], v6 offset:8704
    s_waitcnt lgkmcnt(4)
    v_mfma_f32_32x32x16_bf16 v[16:31], v[56:59], v[92:95], v[16:31]
    ds_read_b64_tr_b16 v[52:53], v7 offset:8192
    ds_read_b64_tr_b16 v[54:55], v7 offset:8704
    s_waitcnt lgkmcnt(4)
    v_mfma_f32_32x32x16_bf16 v[32:47], v[60:63], v[92:95], v[32:47]
    s_waitcnt vmcnt(4)
    ds_read_b64_tr_b16 v[56:57], v6 offset:10240
    ds_read_b64_tr_b16 v[58:59], v6 offset:10752
    s_waitcnt lgkmcnt(4)
    v_mfma_f32_32x32x16_bf16 v[16:31], v[48:51], v[96:99], v[16:31]
    ds_read_b64_tr_b16 v[60:61], v7 offset:10240
    ds_read_b64_tr_b16 v[62:63], v7 offset:10752
    s_waitcnt lgkmcnt(4)
    v_mfma_f32_32x32x16_bf16 v[32:47], v[52:55], v[96:99], v[32:47]
    s_waitcnt vmcnt(3)
    ds_read_b64_tr_b16 v[48:49], v6 offset:12288
    ds_read_b64_tr_b16 v[50:51], v6 offset:12800
    s_waitcnt lgkmcnt(4)
    v_mfma_f32_32x32x16_bf16 v[16:31], v[56:59], v[100:103], v[16:31]
    ds_read_b64_tr_b16 v[52:53], v7 offset:12288
    ds_read_b64_tr_b16 v[54:55], v7 offset:12800
    s_waitcnt lgkmcnt(4)
    v_mfma_f32_32x32x16_bf16 v[32:47], v[60:63], v[100:103], v[32:47]
    s_waitcnt vmcnt(2)
    ds_read_b64_tr_b16 v[56:57], v6 offset:14336
    ds_read_b64_tr_b16 v[58:59], v6 offset:14848
    s_waitcnt lgkmcnt(4)
    v_mfma_f32_32x32x16_bf16 v[16:31], v[48:51], v[104:107], v[16:31]
    ds_read_b64_tr_b16 v[60:61], v7 offset:14336
    ds_read_b64_tr_b16 v[62:63], v7 offset:14848
    s_waitcnt lgkmcnt(4)
    v_mfma_f32_32x32x16_bf16 v[32:47], v[52:55], v[104:107], v[32:47]
    s_waitcnt vmcnt(1)
    s_waitcnt lgkmcnt(2)
    v_mfma_f32_32x32x16_bf16 v[16:31], v[56:59], v[108:111], v[16:31]
    s_waitcnt lgkmcnt(0)
    v_mfma_f32_32x32x16_bf16 v[32:47], v[60:63], v[108:111], v[32:47]
    s_nop 9
    s_cmp_eq_u32 s12, 1
    s_cbranch_scc1 rv_51
    s_cmp_eq_u32 s12, 2
    s_cbranch_scc1 rv_52
    s_cmp_eq_u32 s12, 3
    s_cbranch_scc1 rv_53
rv_50:
    ds_write_b128 v8, v[24:27] offset:10240
    ds_write_b128 v8, v[28:31] offset:11264
    ds_write_b128 v8, v[32:35] offset:14336
    ds_write_b128 v8, v[36:39] offset:15360
    ds_write_b128 v8, v[40:43] offset:18432
    ds_write_b128 v8, v[44:47] offset:19456
    v_mov_b32 v48, v16
    v_mov_b32 v49, v17
    v_mov_b32 v50, v18
    v_mov_b32 v51, v19
    v_mov_b32 v52, v20
    v_mov_b32 v53, v21
    v_mov_b32 v54, v22
    v_mov_b32 v55, v23
    s_branch rdone_49
rv_51:
    ds_write_b128 v8, v[16:19] offset:0
    ds_write_b128 v8, v[20:23] offset:1024
    ds_write_b128 v8, v[32:35] offset:16384
    ds_write_b128 v8, v[36:39] offset:17408
    ds_write_b128 v8, v[40:43] offset:20480
    ds_write_b128 v8, v[44:47] offset:21504
    v_mov_b32 v48, v24
    v_mov_b32 v49, v25
    v_mov_b32 v50, v26
    v_mov_b32 v51, v27
    v_mov_b32 v52, v28
    v_mov_b32 v53, v29
    v_mov_b32 v54, v30
    v_mov_b32 v55, v31
    s_branch rdone_49
rv_52:
    ds_write_b128 v8, v[16:19] offset:2048
    ds_write_b128 v8, v[20:23] offset:3072
    ds_write_b128 v8, v[24:27] offset:6144
    ds_write_b128 v8, v[28:31] offset:7168
    ds_write_b128 v8, v[40:43] offset:22528
    ds_write_b128 v8, v[44:47] offset:23552
    v_mov_b32 v48, v32
    v_mov_b32 v49, v33
    v_mov_b32 v50, v34
    v_mov_b32 v51, v35
    v_mov_b32 v52, v36
    v_mov_b32 v53, v37
    v_mov_b32 v54, v38
    v_mov_b32 v55, v39
    s_branch rdone_49
rv_53:
    ds_write_b128 v8, v[16:19] offset:4096
    ds_write_b128 v8, v[20:23] offset:5120
    ds_write_b128 v8, v[24:27] offset:8192
    ds_write_b128 v8, v[28:31] offset:9216
    ds_write_b128 v8, v[32:35] offset:12288
    ds_write_b128 v8, v[36:39] offset:13312
    v_mov_b32 v48, v40
    v_mov_b32 v49, v41
    v_mov_b32 v50, v42
    v_mov_b32 v51, v43
    v_mov_b32 v52, v44
    v_mov_b32 v53, v45
    v_mov_b32 v54, v46
    v_mov_b32 v55, v47
rdone_49:
    s_mul_i32 s6, s12, 6144
    v_add_u32 v8, s6, v8
    s_waitcnt lgkmcnt(0)
    s_barrier
    ds_read_b128 v[56:59], v8 offset:0
    ds_read_b128 v[60:63], v8 offset:1024
    ds_read_b128 v[64:67], v8 offset:2048
    ds_read_b128 v[68:71], v8 offset:3072
    ds_read_b128 v[72:75], v8 offset:4096
    ds_read_b128 v[76:79], v8 offset:5120
    v_lshlrev_b32 v16, 16, v248
    v_and_b32 v17, 0xffff0000, v248
    v_lshlrev_b32 v18, 16, v249
    v_and_b32 v19, 0xffff0000, v249
    v_lshlrev_b32 v20, 16, v250
    v_and_b32 v21, 0xffff0000, v250
    v_lshlrev_b32 v22, 16, v251
    v_and_b32 v23, 0xffff0000, v251
    v_pk_add_f32 v[48:49], v[48:49], v[16:17]
    v_pk_add_f32 v[50:51], v[50:51], v[18:19]
    v_pk_add_f32 v[52:53], v[52:53], v[20:21]
    v_pk_add_f32 v[54:55], v[54:55], v[22:23]
    s_waitcnt lgkmcnt(4)
    v_pk_add_f32 v[48:49], v[48:49], v[56:57]
    v_pk_add_f32 v[50:51], v[50:51], v[58:59]
    v_pk_add_f32 v[52:53], v[52:53], v[60:61]
    v_pk_add_f32 v[54:55], v[54:55], v[62:63]
    s_waitcnt lgkmcnt(2)
    v_pk_add_f32 v[48:49], v[48:49], v[64:65]
    v_pk_add_f32 v[50:51], v[50:51], v[66:67]
    v_pk_add_f32 v[52:53], v[52:53], v[68:69]
    v_pk_add_f32 v[54:55], v[54:55], v[70:71]
    s_waitcnt lgkmcnt(0)
    v_pk_add_f32 v[48:49], v[48:49], v[72:73]
    v_pk_add_f32 v[50:51], v[50:51], v[74:75]
    v_pk_add_f32 v[52:53], v[52:53], v[76:77]
    v_pk_add_f32 v[54:55], v[54:55], v[78:79]
    v_cvt_pk_bf16_f32 v248, v48, v49
    v_cvt_pk_bf16_f32 v249, v50, v51
    v_cvt_pk_bf16_f32 v250, v52, v53
    v_cvt_pk_bf16_f32 v251, v54, v55
    s_cmp_eq_u32 s54, 0
    s_cbranch_scc1 gs_54
    buffer_store_dwordx4 v[248:251], v4, s[28:31], 0 offen
    s_branch gd_55
gs_54:
    buffer_store_dwordx4 v[248:251], v4, s[28:31], 0 offen sc1
gd_55:
    v_dot2_f32_bf16 v16, v248, s15, 0
    v_dot2_f32_bf16 v17, v248, v248, 0
    v_dot2_f32_bf16 v16, v249, s15, v16
    v_dot2_f32_bf16 v17, v249, v249, v17
    v_dot2_f32_bf16 v16, v250, s15, v16
    v_dot2_f32_bf16 v17, v250, v250, v17
    v_dot2_f32_bf16 v16, v251, s15, v16
    v_dot2_f32_bf16 v17, v251, v251, v17
    s_lshl_b32 s6, s3, 8
    s_add_u32 s6, s6, 0xc000
    v_lshl_add_u32 v9, v1, 2, s6
    s_nop 1
    v_permlane32_swap_b32 v16, v17
    s_nop 0
    v_add_f32 v16, v16, v17
    ds_write_b32 v9, v16
    s_waitcnt lgkmcnt(0)
    s_barrier
    s_cmp_lg_u32 s12, 0
    s_cbranch_scc1 nost_56
    ds_read_b32 v18, v9 offset:256
    ds_read_b32 v19, v9 offset:512
    ds_read_b32 v20, v9 offset:768
    s_lshl_b32 s6, s66, 3
    s_add_u32 s6, s6, s11
    s_lshl_b32 s6, s6, 8
    v_lshl_add_u32 v9, v1, 2, s6
    s_waitcnt lgkmcnt(0)
    v_add_f32 v16, v16, v18
    v_add_f32 v19, v19, v20
    v_add_f32 v16, v16, v19
    s_cmp_eq_u32 s54, 0
    s_cbranch_scc1 gs_57
    buffer_store_dword v16, v9, s[32:35], 0 offen
    s_branch gd_58
gs_57:
    buffer_store_dword v16, v9, s[32:35], 0 offen sc1
gd_58:
nost_56:
    s_waitcnt vmcnt(0)
    s_barrier
    s_cmp_lg_u32 s3, 0
    s_cbranch_scc1 nopub_59
    s_lshl_b32 s6, s4, 7
    s_lshl_b32 s7, s5, 2
    s_add_u32 s6, s6, s7
    v_mov_b32 v2, s6
    v_mov_b32 v3, s55
    s_mov_b64 exec, 1
    s_add_u32 s8, s101, 1024
    s_cmp_eq_u32 s54, 0
    s_cbranch_scc1 gs_60
    buffer_store_dword v3, v2, s[96:99], s8 offen
    s_branch gd_61
gs_60:
    buffer_store_dword v3, v2, s[96:99], s8 offen sc1
gd_61:
    s_mov_b64 exec, -1
nopub_59:
    s_cmp_ge_u32 s5, 14
    s_cselect_b32 s6, 1, 0
    s_cselect_b32 s7, 14, 0
    s_sub_u32 s11, s5, s7
    s_lshl_b32 s10, s4, 1
    s_add_u32 s10, s10, s6
    s_add_u32 s16, s52, 0x200000
    s_addc_u32 s17, s53, 0
    s_mov_b32 s18, 0x200000
    s_mov_b32 s19, 0x20000
    s_mov_b32 s20, s44
    s_mov_b32 s21, s45
    s_mov_b32 s22, 0x1c0000
    s_mov_b32 s23, 0x20000
    s_add_u32 s28, s52, 0x400000
    s_addc_u32 s29, s53, 0
    s_mov_b32 s30, 0x700000
    s_mov_b32 s31, 0x20000
    s_add_u32 s32, s52, 0xe00000
    s_addc_u32 s33, s53, 0
    s_mov_b32 s34, 0x20000
    s_mov_b32 s35, 0x20000
    s_sub_u32 s56, s3, 4
    s_cmp_ge_u32 s5, 28
    s_cbranch_scc1 p3skip_64
    s_cmp_ge_u32 s3, 4
    s_cbranch_scc1 p3ld_62
    s_setprio 1
    s_lshl_b32 s56, s10, 2
    s_add_u32 s56, s56, s3
    s_lshl_b32 s6, s56, 15
    v_lshl_add_u32 v12, v1, 4, s6
    s_lshl_b32 s6, s56, 11
    v_lshl_add_u32 v13, v1, 2, s6
    v_bfe_u32 v9, v1, 2, 2
    v_lshrrev_b32 v10, 5, v1
    v_lshl_add_u32 v4, v10, 3, v9
    v_lshlrev_b32 v4, 7, v4
    v_lshrrev_b32 v9, 1, v9
    v_lshlrev_b32 v9, 2, v9
    v_lshl_or_b32 v9, v10, 1, v9
    v_bfe_u32 v10, v1, 4, 1
    v_and_b32 v11, 1, v1
    v_lshl_or_b32 v10, v10, 1, v11
    v_bfe_u32 v11, v1, 1, 1
    v_xor_b32 v9, v9, v10
    v_lshl_add_u32 v4, v9, 4, v4
    v_lshl_add_u32 v4, v11, 3, v4
    v_xor_b32 v5, 64, v4
    v_add_u32 v6, 0x10000, v4
    v_add_u32 v7, 0x10000, v5
    s_and_b32 s58, s10, 1
    s_lshl_b32 s58, s58, 4
    s_cmp_lg_u32 s3, 0
    s_cbranch_scc1 nopoll_66
    s_lshl_b32 s6, s4, 7
    s_lshl_b32 s7, s58, 2
    s_add_u32 s6, s6, s7
    s_add_u32 s6, s6, 1024
    s_add_u32 s6, s6, s101
    v_min_u32 v2, 15, v1
    v_lshl_add_u32 v2, v2, 2, s6
    s_mov_b32 s9, 0
spin_67:
    buffer_load_dword v3, v2, s[96:99], 0 offen sc1
    s_waitcnt vmcnt(0)
    v_cmp_ne_u32 vcc, s55, v3
    s_add_u32 s9, s9, 1
    s_cmp_gt_u32 s9, 0x40000
    s_cbranch_scc1 spun_68
    s_cbranch_vccnz spin_67
spun_68:
    s_cmp_lg_u32 s54, 0
    s_cbranch_scc1 nopoll_66
    buffer_inv sc1
    s_waitcnt vmcnt(0)
nopoll_66:
    s_barrier
    buffer_load_dwordx4 v[120:123], v12, s[16:19], 0 offen offset:0 sc1
    buffer_load_dwordx4 v[124:127], v12, s[16:19], 0 offen offset:1024 sc1
    buffer_load_dwordx4 v[128:131], v12, s[16:19], 0 offen offset:2048 sc1
    buffer_load_dwordx4 v[132:135], v12, s[16:19], 0 offen offset:3072 sc1
    s_mov_b32 s8, 0x1000
    buffer_load_dwordx4 v[136:139], v12, s[16:19], s8 offen offset:0 sc1
    buffer_load_dwordx4 v[140:143], v12, s[16:19], s8 offen offset:1024 sc1
    buffer_load_dwordx4 v[144:147], v12, s[16:19], s8 offen offset:2048 sc1
    buffer_load_dwordx4 v[148:151], v12, s[16:19], s8 offen offset:3072 sc1
    s_barrier
    ds_read_b64_tr_b16 v[88:89], v4 offset:0
    ds_read_b64_tr_b16 v[90:91], v4 offset:512
    ds_read_b64_tr_b16 v[92:93], v5 offset:0
    ds_read_b64_tr_b16 v[94:95], v5 offset:512
    ds_read_b64_tr_b16 v[96:97], v6 offset:0
    ds_read_b64_tr_b16 v[98:99], v6 offset:512
    ds_read_b64_tr_b16 v[100:101], v7 offset:0
    ds_read_b64_tr_b16 v[102:103], v7 offset:512
    s_mov_b32 s8, 0x2000
    buffer_load_dwordx4 v[152:155], v12, s[16:19], s8 offen offset:0 sc1
    buffer_load_dwordx4 v[156:159], v12, s[16:19], s8 offen offset:1024 sc1
    s_waitcnt vmcnt(9)
    ds_read_b64_tr_b16 v[104:105], v4 offset:2048
    ds_read_b64_tr_b16 v[106:107], v4 offset:2560
    s_waitcnt lgkmcnt(8)
    v_mfma_f32_32x32x16_bf16 v[24:39], v[88:91], v[120:123], 0
    ds_read_b64_tr_b16 v[108:109], v5 offset:2048
    ds_read_b64_tr_b16 v[110:111], v5 offset:2560
    s_waitcnt lgkmcnt(8)
    v_mfma_f32_32x32x16_bf16 v[40:55], v[92:95], v[120:123], 0
    ds_read_b64_tr_b16 v[112:113], v6 offset:2048
    ds_read_b64_tr_b16 v[114:115], v6 offset:2560
    s_waitcnt lgkmcnt(8)
    v_mfma_f32_32x32x16_bf16 v[56:71], v[96:99], v[120:123], 0
    ds_read_b64_tr_b16 v[116:117], v7 offset:2048
    ds_read_b64_tr_b16 v[118:119], v7 offset:2560
    s_waitcnt lgkmcnt(8)
    v_mfma_f32_32x32x16_bf16 v[72:87], v[100:103], v[120:123], 0
    buffer_load_dwordx4 v[160:163], v12, s[16:19], s8 offen offset:2048 sc1
    buffer_load_dwordx4 v[164:167], v12, s[16:19], s8 offen offset:3072 sc1
    s_waitcnt vmcnt(10)
    ds_read_b64_tr_b16 v[88:89], v4 offset:4096
    ds_read_b64_tr_b16 v[90:91], v4 offset:4608
    s_waitcnt lgkmcnt(8)
    v_mfma_f32_32x32x16_bf16 v[24:39], v[104:107], v[124:127], v[24:39]
    ds_read_b64_tr_b16 v[92:93], v5 offset:4096
    ds_read_b64_tr_b16 v[94:95], v5 offset:4608
    s_waitcnt lgkmcnt(8)
    v_mfma_f32_32x32x16_bf16 v[40:55], v[108:111], v[124:127], v[40:55]
    ds_read_b64_tr_b16 v[96:97], v6 offset:4096
    ds_read_b64_tr_b16 v[98:99], v6 offset:4608
    s_waitcnt lgkmcnt(8)
    v_mfma_f32_32x32x16_bf16 v[56:71], v[112:115], v[124:127], v[56:71]
    ds_read_b64_tr_b16 v[100:101], v7 offset:4096
    ds_read_b64_tr_b16 v[102:103], v7 offset:4608
    s_waitcnt lgkmcnt(8)
    v_mfma_f32_32x32x16_bf16 v[72:87], v[116:119], v[124:127], v[72:87]
    s_mov_b32 s8, 0x3000
    buffer_load_dwordx4 v[168:171], v12, s[16:19], s8 offen offset:0 sc1
    buffer_load_dwordx4 v[172:175], v12, s[16:19], s8 offen offset:1024 sc1
    s_waitcnt vmcnt(11)
    ds_read_b64_tr_b16 v[104:105], v4 offset:6144
    ds_read_b64_tr_b16 v[106:107], v4 offset:6656
    s_waitcnt lgkmcnt(8)
    v_mfma_f32_32x32x16_bf16 v[24:39], v[88:91], v[128:131], v[24:39]
    ds_read_b64_tr_b16 v[108:109], v5 offset:6144
    ds_read_b64_tr_b16 v[110:111], v5 offset:6656
    s_waitcnt lgkmcnt(8)
    v_mfma_f32_32x32x16_bf16 v[40:55], v[92:95], v[128:131], v[40:55]
    ds_read_b64_tr_b16 v[112:113], v6 offset:6144
    ds_read_b64_tr_b16 v[114:115], v6 offset:6656
    s_waitcnt lgkmcnt(8)
    v_mfma_f32_32x32x16_bf16 v[56:71], v[96:99], v[128:131], v[56:71]
    ds_read_b64_tr_b16 v[116:117], v7 offset:6144
    ds_read_b64_tr_b16 v[118:119], v7 offset:6656
    s_waitcnt lgkmcnt(8)
    v_mfma_f32_32x32x16_bf16 v[72:87], v[100:103], v[128:131], v[72:87]
    buffer_load_dwordx4 v[176:179], v12, s[16:19], s8 offen offset:2048 sc1
    buffer_load_dwordx4 v[180:183], v12, s[16:19], s8 offen offset:3072 sc1
    s_barrier
    s_waitcnt vmcnt(12)
    ds_read_b64_tr_b16 v[88:89], v4 offset:8192
    ds_read_b64_tr_b16 v[90:91], v4 offset:8704
    s_waitcnt lgkmcnt(8)
    v_mfma_f32_32x32x16_bf16 v[24:39], v[104:107], v[132:135], v[24:39]
    ds_read_b64_tr_b16 v[92:93], v5 offset:8192
    ds_read_b64_tr_b16 v[94:95], v5 offset:8704
    s_waitcnt lgkmcnt(8)
    v_mfma_f32_32x32x16_bf16 v[40:55], v[108:111], v[132:135], v[40:55]
    ds_read_b64_tr_b16 v[96:97], v6 offset:8192
    ds_read_b64_tr_b16 v[98:99], v6 offset:8704
    s_waitcnt lgkmcnt(8)
    v_mfma_f32_32x32x16_bf16 v[56:71], v[112:115], v[132:135], v[56:71]
    ds_read_b64_tr_b16 v[100:101], v7 offset:8192
    ds_read_b64_tr_b16 v[102:103], v7 offset:8704
    s_waitcnt lgkmcnt(8)
    v_mfma_f32_32x32x16_bf16 v[72:87], v[116:119], v[132:135], v[72:87]
    s_mov_b32 s8, 0x4000
    buffer_load_dwordx4 v[184:187], v12, s[16:19], s8 offen offset:0 sc1
    buffer_load_dwordx4 v[188:191], v12, s[16:19], s8 offen offset:1024 sc1
    s_waitcnt vmcnt(13)
    ds_read_b64_tr_b16 v[104:105], v4 offset:10240
    ds_read_b64_tr_b16 v[106:107], v4 offset:10752
    s_waitcnt lgkmcnt(8)
    v_mfma_f32_32x32x16_bf16 v[24:39], v[88:91], v[136:139], v[24:39]
    ds_read_b64_tr_b16 v[108:109], v5 offset:10240
    ds_read_b64_tr_b16 v[110:111], v5 offset:10752
    s_waitcnt lgkmcnt(8)
    v_mfma_f32_32x32x16_bf16 v[40:55], v[92:95], v[136:139], v[40:55]
    ds_read_b64_tr_b16 v[112:113], v6 offset:10240
    ds_read_b64_tr_b16 v[114:115], v6 offset:10752
    s_waitcnt lgkmcnt(8)
    v_mfma_f32_32x32x16_bf16 v[56:71], v[96:99], v[136:139], v[56:71]
    ds_read_b64_tr_b16 v[116:117], v7 offset:10240
    ds_read_b64_tr_b16 v[118:119], v7 offset:10752
    s_waitcnt lgkmcnt(8)
    v_mfma_f32_32x32x16_bf16 v[72:87], v[100:103], v[136:139], v[72:87]
    buffer_load_dwordx4 v[192:195], v12, s[16:19], s8 offen offset:2048 sc1
    buffer_load_dwordx4 v[196:199], v12, s[16:19], s8 offen offset:3072 sc1
    s_waitcnt vmcnt(14)
    ds_read_b64_tr_b16 v[88:89], v4 offset:12288
    ds_read_b64_tr_b16 v[90:91], v4 offset:12800
    s_waitcnt lgkmcnt(8)
    v_mfma_f32_32x32x16_bf16 v[24:39], v[104:107], v[140:143], v[24:39]
    ds_read_b64_tr_b16 v[92:93], v5 offset:12288
    ds_read_b64_tr_b16 v[94:95], v5 offset:12800
    s_waitcnt lgkmcnt(8)
    v_mfma_f32_32x32x16_bf16 v[40:55], v[108:111], v[140:143], v[40:55]
    ds_read_b64_tr_b16 v[96:97], v6 offset:12288
    ds_read_b64_tr_b16 v[98:99], v6 offset:12800
    s_waitcnt lgkmcnt(8)
    v_mfma_f32_32x32x16_bf16 v[56:71], v[112:115], v[140:143], v[56:71]
    ds_read_b64_tr_b16 v[100:101], v7 offset:12288
    ds_read_b64_tr_b16 v[102:103], v7 offset:12800
    s_waitcnt lgkmcnt(8)
    v_mfma_f32_32x32x16_bf16 v[72:87], v[116:119], v[140:143], v[72:87]
    s_mov_b32 s8, 0x5000
    buffer_load_dwordx4 v[200:203], v12, s[16:19], s8 offen offset:0 sc1
    buffer_load_dwordx4 v[204:207], v12, s[16:19], s8 offen offset:1024 sc1
    s_waitcnt vmcnt(15)
    ds_read_b64_tr_b16 v[104:105], v4 offset:14336
    ds_read_b64_tr_b16 v[106:107], v4 offset:14848
    s_waitcnt lgkmcnt(8)
    v_mfma_f32_32x32x16_bf16 v[24:39], v[88:91], v[144:147], v[24:39]
    ds_read_b64_tr_b16 v[108:109], v5 offset:14336
    ds_read_b64_tr_b16 v[110:111], v5 offset:14848
    s_waitcnt lgkmcnt(8)
    v_mfma_f32_32x32x16_bf16 v[40:55], v[92:95], v[144:147], v[40:55]
    ds_read_b64_tr_b16 v[112:113], v6 offset:14336
    ds_read_b64_tr_b16 v[114:115], v6 offset:14848
    s_waitcnt lgkmcnt(8)
    v_mfma_f32_32x32x16_bf16 v[56:71], v[96:99], v[144:147], v[56:71]
    ds_read_b64_tr_b16 v[116:117], v7 offset:14336
    ds_read_b64_tr_b16 v[118:119], v7 offset:14848
    s_waitcnt lgkmcnt(8)
    v_mfma_f32_32x32x16_bf16 v[72:87], v[100:103], v[144:147], v[72:87]
    buffer_load_dwordx4 v[208:211], v12, s[16:19], s8 offen offset:2048 sc1
    buffer_load_dwordx4 v[212:215], v12, s[16:19], s8 offen offset:3072 sc1
    s_barrier
    s_waitcnt vmcnt(16)
    ds_read_b64_tr_b16 v[88:89], v4 offset:16384
    ds_read_b64_tr_b16 v[90:91], v4 offset:16896
    s_waitcnt lgkmcnt(8)
    v_mfma_f32_32x32x16_bf16 v[24:39], v[104:107], v[148:151], v[24:39]
    ds_read_b64_tr_b16 v[92:93], v5 offset:16384
    ds_read_b64_tr_b16 v[94:95], v5 offset:16896
    s_waitcnt lgkmcnt(8)
    v_mfma_f32_32x32x16_bf16 v[40:55], v[108:111], v[148:151], v[40:55]
    ds_read_b64_tr_b16 v[96:97], v6 offset:16384
    ds_read_b64_tr_b16 v[98:99], v6 offset:16896
    s_waitcnt lgkmcnt(8)
    v_mfma_f32_32x32x16_bf16 v[56:71], v[112:115], v[148:151], v[56:71]
    ds_read_b64_tr_b16 v[100:101], v7 offset:16384
    ds_read_b64_tr_b16 v[102:103], v7 offset:16896
    s_waitcnt lgkmcnt(8)
    v_mfma_f32_32x32x16_bf16 v[72:87], v[116:119], v[148:151], v[72:87]
    s_mov_b32 s8, 0x6000
    buffer_load_dwordx4 v[216:219], v12, s[16:19], s8 offen offset:0 sc1
    buffer_load_dwordx4 v[220:223], v12, s[16:19], s8 offen offset:1024 sc1
    s_waitcnt vmcnt(17)
    ds_read_b64_tr_b16 v[104:105], v4 offset:18432
    ds_read_b64_tr_b16 v[106:107], v4 offset:18944
    s_waitcnt lgkmcnt(8)
    v_mfma_f32_32x32x16_bf16 v[24:39], v[88:91], v[152:155], v[24:39]
    ds_read_b64_tr_b16 v[108:109], v5 offset:18432
    ds_read_b64_tr_b16 v[110:111], v5 offset:18944
    s_waitcnt lgkmcnt(8)
    v_mfma_f32_32x32x16_bf16 v[40:55], v[92:95], v[152:155], v[40:55]
    ds_read_b64_tr_b16 v[112:113], v6 offset:18432
    ds_read_b64_tr_b16 v[114:115], v6 offset:18944
    s_waitcnt lgkmcnt(8)
    v_mfma_f32_32x32x16_bf16 v[56:71], v[96:99], v[152:155], v[56:71]
    ds_read_b64_tr_b16 v[116:117], v7 offset:18432
    ds_read_b64_tr_b16 v[118:119], v7 offset:18944
    s_waitcnt lgkmcnt(8)
    v_mfma_f32_32x32x16_bf16 v[72:87], v[100:103], v[152:155], v[72:87]
    buffer_load_dwordx4 v[224:227], v12, s[16:19], s8 offen offset:2048 sc1
    buffer_load_dwordx4 v[228:231], v12, s[16:19], s8 offen offset:3072 sc1
    s_waitcnt vmcnt(18)
    ds_read_b64_tr_b16 v[88:89], v4 offset:20480
    ds_read_b64_tr_b16 v[90:91], v4 offset:20992
    s_waitcnt lgkmcnt(8)
    v_mfma_f32_32x32x16_bf16 v[24:39], v[104:107], v[156:159], v[24:39]
    ds_read_b64_tr_b16 v[92:93], v5 offset:20480
    ds_read_b64_tr_b16 v[94:95], v5 offset:20992
    s_waitcnt lgkmcnt(8)
    v_mfma_f32_32x32x16_bf16 v[40:55], v[108:111], v[156:159], v[40:55]
    ds_read_b64_tr_b16 v[96:97], v6 offset:20480
    ds_read_b64_tr_b16 v[98:99], v6 offset:20992
    s_waitcnt lgkmcnt(8)
    v_mfma_f32_32x32x16_bf16 v[56:71], v[112:115], v[156:159], v[56:71]
    ds_read_b64_tr_b16 v[100:101], v7 offset:20480
    ds_read_b64_tr_b16 v[102:103], v7 offset:20992
    s_waitcnt lgkmcnt(8)
    v_mfma_f32_32x32x16_bf16 v[72:87], v[116:119], v[156:159], v[72:87]
    s_mov_b32 s8, 0x7000
    buffer_load_dwordx4 v[232:235], v12, s[16:19], s8 offen offset:0 sc1
    buffer_load_dwordx4 v[236:239], v12, s[16:19], s8 offen offset:1024 sc1
    s_waitcnt vmcnt(19)
    ds_read_b64_tr_b16 v[104:105], v4 offset:22528
    ds_read_b64_tr_b16 v[106:107], v4 offset:23040
    s_waitcnt lgkmcnt(8)
    v_mfma_f32_32x32x16_bf16 v[24:39], v[88:91], v[160:163], v[24:39]
    ds_read_b64_tr_b16 v[108:109], v5 offset:22528
    ds_read_b64_tr_b16 v[110:111], v5 offset:23040
    s_waitcnt lgkmcnt(8)
    v_mfma_f32_32x32x16_bf16 v[40:55], v[92:95], v[160:163], v[40:55]
    ds_read_b64_tr_b16 v[112:113], v6 offset:22528
    ds_read_b64_tr_b16 v[114:115], v6 offset:23040
    s_waitcnt lgkmcnt(8)
    v_mfma_f32_32x32x16_bf16 v[56:71], v[96:99], v[160:163], v[56:71]
    ds_read_b64_tr_b16 v[116:117], v7 offset:22528
    ds_read_b64_tr_b16 v[118:119], v7 offset:23040
    s_waitcnt lgkmcnt(8)
    v_mfma_f32_32x32x16_bf16 v[72:87], v[100:103], v[160:163], v[72:87]
    buffer_load_dwordx4 v[240:243], v12, s[16:19], s8 offen offset:2048 sc1
    buffer_load_dwordx4 v[244:247], v12, s[16:19], s8 offen offset:3072 sc1
    s_barrier
    s_waitcnt vmcnt(20)
    ds_read_b64_tr_b16 v[88:89], v4 offset:24576
    ds_read_b64_tr_b16 v[90:91], v4 offset:25088
    s_waitcnt lgkmcnt(8)
    v_mfma_f32_32x32x16_bf16 v[24:39], v[104:107], v[164:167], v[24:39]
    ds_read_b64_tr_b16 v[92:93], v5 offset:24576
    ds_read_b64_tr_b16 v[94:95], v5 offset:25088
    s_waitcnt lgkmcnt(8)
    v_mfma_f32_32x32x16_bf16 v[40:55], v[108:111], v[164:167], v[40:55]
    ds_read_b64_tr_b16 v[96:97], v6 offset:24576
    ds_read_b64_tr_b16 v[98:99], v6 offset:25088
    s_waitcnt lgkmcnt(8)
    v_mfma_f32_32x32x16_bf16 v[56:71], v[112:115], v[164:167], v[56:71]
    ds_read_b64_tr_b16 v[100:101], v7 offset:24576
    ds_read_b64_tr_b16 v[102:103], v7 offset:25088
    s_waitcnt lgkmcnt(8)
    v_mfma_f32_32x32x16_bf16 v[72:87], v[116:119], v[164:167], v[72:87]
    buffer_load_dword v16, v13, s[32:35], 0 offen offset:0 sc1
    buffer_load_dword v17, v13, s[32:35], 0 offen offset:256 sc1
    buffer_load_dword v18, v13, s[32:35], 0 offen offset:512 sc1
    buffer_load_dword v19, v13, s[32:35], 0 offen offset:768 sc1
    buffer_load_dword v20, v13, s[32:35], 0 offen offset:1024 sc1
    buffer_load_dword v21, v13, s[32:35], 0 offen offset:1280 sc1
    buffer_load_dword v22, v13, s[32:35], 0 offen offset:1536 sc1
    buffer_load_dword v23, v13, s[32:35], 0 offen offset:1792 sc1
    s_mul_i32 s6, s56, 114688
    s_lshl_b32 s7, s11, 13
    s_add_u32 s6, s6, s7
    v_lshl_add_u32 v13, v1, 4, s6
    s_waitcnt vmcnt(27)
    ds_read_b64_tr_b16 v[104:105], v4 offset:26624
    ds_read_b64_tr_b16 v[106:107], v4 offset:27136
    s_waitcnt lgkmcnt(8)
    v_mfma_f32_32x32x16_bf16 v[24:39], v[88:91], v[168:171], v[24:39]
    ds_read_b64_tr_b16 v[108:109], v5 offset:26624
    ds_read_b64_tr_b16 v[110:111], v5 offset:27136
    s_waitcnt lgkmcnt(8)
    v_mfma_f32_32x32x16_bf16 v[40:55], v[92:95], v[168:171], v[40:55]
    ds_read_b64_tr_b16 v[112:113], v6 offset:26624
    ds_read_b64_tr_b16 v[114:115], v6 offset:27136
    s_waitcnt lgkmcnt(8)
    v_mfma_f32_32x32x16_bf16 v[56:71], v[96:99], v[168:171], v[56:71]
    ds_read_b64_tr_b16 v[116:117], v7 offset:26624
    ds_read_b64_tr_b16 v[118:119], v7 offset:27136
    s_waitcnt lgkmcnt(8)
    v_mfma_f32_32x32x16_bf16 v[72:87], v[100:103], v[168:171], v[72:87]
    s_waitcnt vmcnt(26)
    ds_read_b64_tr_b16 v[88:89], v4 offset:28672
    ds_read_b64_tr_b16 v[90:91], v4 offset:29184
    s_waitcnt lgkmcnt(8)
    v_mfma_f32_32x32x16_bf16 v[24:39], v[104:107], v[172:175], v[24:39]
    ds_read_b64_tr_b16 v[92:93], v5 offset:28672
    ds_read_b64_tr_b16 v[94:95], v5 offset:29184
    s_waitcnt lgkmcnt(8)
    v_mfma_f32_32x32x16_bf16 v[40:55], v[108:111], v[172:175], v[40:55]
    ds_read_b64_tr_b16 v[96:97], v6 offset:28672
    ds_read_b64_tr_b16 v[98:99], v6 offset:29184
    s_waitcnt lgkmcnt(8)
    v_mfma_f32_32x32x16_bf16 v[56:71], v[112:115], v[172:175], v[56:71]
    ds_read_b64_tr_b16 v[100:101], v7 offset:28672
    ds_read_b64_tr_b16 v[102:103], v7 offset:29184
    s_waitcnt lgkmcnt(8)
    v_mfma_f32_32x32x16_bf16 v[72:87], v[116:119], v[172:175], v[72:87]
    s_waitcnt vmcnt(25)
    ds_read_b64_tr_b16 v[104:105], v4 offset:30720
    ds_read_b64_tr_b16 v[106:107], v4 offset:31232
    s_waitcnt lgkmcnt(8)
    v_mfma_f32_32x32x16_bf16 v[24:39], v[88:91], v[176:179], v[24:39]
    ds_read_b64_tr_b16 v[108:109], v5 offset:30720
    ds_read_b64_tr_b16 v[110:111], v5 offset:31232
    s_waitcnt lgkmcnt(8)
    v_mfma_f32_32x32x16_bf16 v[40:55], v[92:95], v[176:179], v[40:55]
    ds_read_b64_tr_b16 v[112:113], v6 offset:30720
    ds_read_b64_tr_b16 v[114:115], v6 offset:31232
    s_waitcnt lgkmcnt(8)
    v_mfma_f32_32x32x16_bf16 v[56:71], v[96:99], v[176:179], v[56:71]
    ds_read_b64_tr_b16 v[116:117], v7 offset:30720
    ds_read_b64_tr_b16 v[118:119], v7 offset:31232
    s_waitcnt lgkmcnt(8)
    v_mfma_f32_32x32x16_bf16 v[72:87], v[100:103], v[176:179], v[72:87]
    s_barrier
    s_waitcnt vmcnt(24)
    ds_read_b64_tr_b16 v[88:89], v4 offset:32768
    ds_read_b64_tr_b16 v[90:91], v4 offset:33280
    s_waitcnt lgkmcnt(8)
    v_mfma_f32_32x32x16_bf16 v[24:39], v[104:107], v[180:183], v[24:39]
    ds_read_b64_tr_b16 v[92:93], v5 offset:32768
    ds_read_b64_tr_b16 v[94:95], v5 offset:33280
    s_waitcnt lgkmcnt(8)
    v_mfma_f32_32x32x16_bf16 v[40:55], v[108:111], v[180:183], v[40:55]
    ds_read_b64_tr_b16 v[96:97], v6 offset:32768
    ds_read_b64_tr_b16 v[98:99], v6 offset:33280
    s_waitcnt lgkmcnt(8)
    v_mfma_f32_32x32x16_bf16 v[56:71], v[112:115], v[180:183], v[56:71]
    ds_read_b64_tr_b16 v[100:101], v7 offset:32768
    ds_read_b64_tr_b16 v[102:103], v7 offset:33280
    s_waitcnt lgkmcnt(8)
    v_mfma_f32_32x32x16_bf16 v[72:87], v[116:119], v[180:183], v[72:87]
    s_waitcnt vmcnt(23)
    ds_read_b64_tr_b16 v[104:105], v4 offset:34816
    ds_read_b64_tr_b16 v[106:107], v4 offset:35328
    s_waitcnt lgkmcnt(8)
    v_mfma_f32_32x32x16_bf16 v[24:39], v[88:91], v[184:187], v[24:39]
    ds_read_b64_tr_b16 v[108:109], v5 offset:34816
    ds_read_b64_tr_b16 v[110:111], v5 offset:35328
    s_waitcnt lgkmcnt(8)
    v_mfma_f32_32x32x16_bf16 v[40:55], v[92:95], v[184:187], v[40:55]
    ds_read_b64_tr_b16 v[112:113], v6 offset:34816
    ds_read_b64_tr_b16 v[114:115], v6 offset:35328
    s_waitcnt lgkmcnt(8)
    v_mfma_f32_32x32x16_bf16 v[56:71], v[96:99], v[184:187], v[56:71]
    ds_read_b64_tr_b16 v[116:117], v7 offset:34816
    ds_read_b64_tr_b16 v[118:119], v7 offset:35328
    s_waitcnt lgkmcnt(8)
    v_mfma_f32_32x32x16_bf16 v[72:87], v[100:103], v[184:187], v[72:87]
    s_waitcnt vmcnt(22)
    ds_read_b64_tr_b16 v[88:89], v4 offset:36864
    ds_read_b64_tr_b16 v[90:91], v4 offset:37376
    s_waitcnt lgkmcnt(8)
    v_mfma_f32_32x32x16_bf16 v[24:39], v[104:107], v[188:191], v[24:39]
    ds_read_b64_tr_b16 v[92:93], v5 offset:36864
    ds_read_b64_tr_b16 v[94:95], v5 offset:37376
    s_waitcnt lgkmcnt(8)
    v_mfma_f32_32x32x16_bf16 v[40:55], v[108:111], v[188:191], v[40:55]
    ds_read_b64_tr_b16 v[96:97], v6 offset:36864
    ds_read_b64_tr_b16 v[98:99], v6 offset:37376
    s_waitcnt lgkmcnt(8)
    v_mfma_f32_32x32x16_bf16 v[56:71], v[112:115], v[188:191], v[56:71]
    ds_read_b64_tr_b16 v[100:101], v7 offset:36864
    ds_read_b64_tr_b16 v[102:103], v7 offset:37376
    s_waitcnt lgkmcnt(8)
    v_mfma_f32_32x32x16_bf16 v[72:87], v[116:119], v[188:191], v[72:87]
    s_waitcnt vmcnt(21)
    ds_read_b64_tr_b16 v[104:105], v4 offset:38912
    ds_read_b64_tr_b16 v[106:107], v4 offset:39424
    s_waitcnt lgkmcnt(8)
    v_mfma_f32_32x32x16_bf16 v[24:39], v[88:91], v[192:195], v[24:39]
    ds_read_b64_tr_b16 v[108:109], v5 offset:38912
    ds_read_b64_tr_b16 v[110:111], v5 offset:39424
    s_waitcnt lgkmcnt(8)
    v_mfma_f32_32x32x16_bf16 v[40:55], v[92:95], v[192:195], v[40:55]
    ds_read_b64_tr_b16 v[112:113], v6 offset:38912
    ds_read_b64_tr_b16 v[114:115], v6 offset:39424
    s_waitcnt lgkmcnt(8)
    v_mfma_f32_32x32x16_bf16 v[56:71], v[96:99], v[192:195], v[56:71]
    ds_read_b64_tr_b16 v[116:117], v7 offset:38912
    ds_read_b64_tr_b16 v[118:119], v7 offset:39424
    s_waitcnt lgkmcnt(8)
    v_mfma_f32_32x32x16_bf16 v[72:87], v[100:103], v[192:195], v[72:87]
    s_waitcnt vmcnt(20)
    ds_read_b64_tr_b16 v[88:89], v4 offset:40960
    ds_read_b64_tr_b16 v[90:91], v4 offset:41472
    s_waitcnt lgkmcnt(8)
    v_mfma_f32_32x32x16_bf16 v[24:39], v[104:107], v[196:199], v[24:39]
    ds_read_b64_tr_b16 v[92:93], v5 offset:40960
    ds_read_b64_tr_b16 v[94:95], v5 offset:41472
    s_waitcnt lgkmcnt(8)
    v_mfma_f32_32x32x16_bf16 v[40:55], v[108:111], v[196:199], v[40:55]
    ds_read_b64_tr_b16 v[96:97], v6 offset:40960
    ds_read_b64_tr_b16 v[98:99], v6 offset:41472
    s_waitcnt lgkmcnt(8)
    v_mfma_f32_32x32x16_bf16 v[56:71], v[112:115], v[196:199], v[56:71]
    ds_read_b64_tr_b16 v[100:101], v7 offset:40960
    ds_read_b64_tr_b16 v[102:103], v7 offset:41472
    s_waitcnt lgkmcnt(8)
    v_mfma_f32_32x32x16_bf16 v[72:87], v[116:119], v[196:199], v[72:87]
    s_waitcnt vmcnt(19)
    ds_read_b64_tr_b16 v[104:105], v4 offset:43008
    ds_read_b64_tr_b16 v[106:107], v4 offset:43520
    s_waitcnt lgkmcnt(8)
    v_mfma_f32_32x32x16_bf16 v[24:39], v[88:91], v[200:203], v[24:39]
    ds_read_b64_tr_b16 v[108:109], v5 offset:43008
    ds_read_b64_tr_b16 v[110:111], v5 offset:43520
    s_waitcnt lgkmcnt(8)
    v_mfma_f32_32x32x16_bf16 v[40:55], v[92:95], v[200:203], v[40:55]
    ds_read_b64_tr_b16 v[112:113], v6 offset:43008
    ds_read_b64_tr_b16 v[114:115], v6 offset:43520
    s_waitcnt lgkmcnt(8)
    v_mfma_f32_32x32x16_bf16 v[56:71], v[96:99], v[200:203], v[56:71]
    ds_read_b64_tr_b16 v[116:117], v7 offset:43008
    ds_read_b64_tr_b16 v[118:119], v7 offset:43520
    s_waitcnt lgkmcnt(8)
    v_mfma_f32_32x32x16_bf16 v[72:87], v[100:103], v[200:203], v[72:87]
    s_waitcnt vmcnt(18)
    ds_read_b64_tr_b16 v[88:89], v4 offset:45056
    ds_read_b64_tr_b16 v[90:91], v4 offset:45568
    s_waitcnt lgkmcnt(8)
    v_mfma_f32_32x32x16_bf16 v[24:39], v[104:107], v[204:207], v[24:39]
    ds_read_b64_tr_b16 v[92:93], v5 offset:45056
    ds_read_b64_tr_b16 v[94:95], v5 offset:45568
    s_waitcnt lgkmcnt(8)
    v_mfma_f32_32x32x16_bf16 v[40:55], v[108:111], v[204:207], v[40:55]
    ds_read_b64_tr_b16 v[96:97], v6 offset:45056
    ds_read_b64_tr_b16 v[98:99], v6 offset:45568
    s_waitcnt lgkmcnt(8)
    v_mfma_f32_32x32x16_bf16 v[56:71], v[112:115], v[204:207], v[56:71]
    ds_read_b64_tr_b16 v[100:101], v7 offset:45056
    ds_read_b64_tr_b16 v[102:103], v7 offset:45568
    s_waitcnt lgkmcnt(8)
    v_mfma_f32_32x32x16_bf16 v[72:87], v[116:119], v[204:207], v[72:87]
    s_waitcnt vmcnt(17)
    ds_read_b64_tr_b16 v[104:105], v4 offset:47104
    ds_read_b64_tr_b16 v[106:107], v4 offset:47616
    s_waitcnt lgkmcnt(8)
    v_mfma_f32_32x32x16_bf16 v[24:39], v[88:91], v[208:211], v[24:39]
    ds_read_b64_tr_b16 v[108:109], v5 offset:47104
    ds_read_b64_tr_b16 v[110:111], v5 offset:47616
    s_waitcnt lgkmcnt(8)
    v_mfma_f32_32x32x16_bf16 v[40:55], v[92:95], v[208:211], v[40:55]
    ds_read_b64_tr_b16 v[112:113], v6 offset:47104
    ds_read_b64_tr_b16 v[114:115], v6 offset:47616
    s_waitcnt lgkmcnt(8)
    v_mfma_f32_32x32x16_bf16 v[56:71], v[96:99], v[208:211], v[56:71]
    ds_read_b64_tr_b16 v[116:117], v7 offset:47104
    ds_read_b64_tr_b16 v[118:119], v7 offset:47616
    s_waitcnt lgkmcnt(8)
    v_mfma_f32_32x32x16_bf16 v[72:87], v[100:103], v[208:211], v[72:87]
    s_waitcnt vmcnt(16)
    ds_read_b64_tr_b16 v[88:89], v4 offset:49152
    ds_read_b64_tr_b16 v[90:91], v4 offset:49664
    s_waitcnt lgkmcnt(8)
    v_mfma_f32_32x32x16_bf16 v[24:39], v[104:107], v[212:215], v[24:39]
    ds_read_b64_tr_b16 v[92:93], v5 offset:49152
    ds_read_b64_tr_b16 v[94:95], v5 offset:49664
    s_waitcnt lgkmcnt(8)
    v_mfma_f32_32x32x16_bf16 v[40:55], v[108:111], v[212:215], v[40:55]
    ds_read_b64_tr_b16 v[96:97], v6 offset:49152
    ds_read_b64_tr_b16 v[98:99], v6 offset:49664
    s_waitcnt lgkmcnt(8)
    v_mfma_f32_32x32x16_bf16 v[56:71], v[112:115], v[212:215], v[56:71]
    ds_read_b64_tr_b16 v[100:101], v7 offset:49152
    ds_read_b64_tr_b16 v[102:103], v7 offset:49664
    s_waitcnt lgkmcnt(8)
    v_mfma_f32_32x32x16_bf16 v[72:87], v[116:119], v[212:215], v[72:87]
    s_waitcnt vmcnt(15)
    ds_read_b64_tr_b16 v[104:105], v4 offset:51200
    ds_read_b64_tr_b16 v[106:107], v4 offset:51712
    s_waitcnt lgkmcnt(8)
    v_mfma_f32_32x32x16_bf16 v[24:39], v[88:91], v[216:219], v[24:39]
    ds_read_b64_tr_b16 v[108:109], v5 offset:51200
    ds_read_b64_tr_b16 v[110:111], v5 offset:51712
    s_waitcnt lgkmcnt(8)
    v_mfma_f32_32x32x16_bf16 v[40:55], v[92:95], v[216:219], v[40:55]
    ds_read_b64_tr_b16 v[112:113], v6 offset:51200
    ds_read_b64_tr_b16 v[114:115], v6 offset:51712
    s_waitcnt lgkmcnt(8)
    v_mfma_f32_32x32x16_bf16 v[56:71], v[96:99], v[216:219], v[56:71]
    ds_read_b64_tr_b16 v[116:117], v7 offset:51200
    ds_read_b64_tr_b16 v[118:119], v7 offset:51712
    s_waitcnt lgkmcnt(8)
    v_mfma_f32_32x32x16_bf16 v[72:87], v[100:103], v[216:219], v[72:87]
    s_waitcnt vmcnt(14)
    ds_read_b64_tr_b16 v[88:89], v4 offset:53248
    ds_read_b64_tr_b16 v[90:91], v4 offset:53760
    s_waitcnt lgkmcnt(8)
    v_mfma_f32_32x32x16_bf16 v[24:39], v[104:107], v[220:223], v[24:39]
    ds_read_b64_tr_b16 v[92:93], v5 offset:53248
    ds_read_b64_tr_b16 v[94:95], v5 offset:53760
    s_waitcnt lgkmcnt(8)
    v_mfma_f32_32x32x16_bf16 v[40:55], v[108:111], v[220:223], v[40:55]
    ds_read_b64_tr_b16 v[96:97], v6 offset:53248
    ds_read_b64_tr_b16 v[98:99], v6 offset:53760
    s_waitcnt lgkmcnt(8)
    v_mfma_f32_32x32x16_bf16 v[56:71], v[112:115], v[220:223], v[56:71]
    ds_read_b64_tr_b16 v[100:101], v7 offset:53248
    ds_read_b64_tr_b16 v[102:103], v7 offset:53760
    s_waitcnt lgkmcnt(8)
    v_mfma_f32_32x32x16_bf16 v[72:87], v[116:119], v[220:223], v[72:87]
    s_waitcnt vmcnt(13)
    ds_read_b64_tr_b16 v[104:105], v4 offset:55296
    ds_read_b64_tr_b16 v[106:107], v4 offset:55808
    s_waitcnt lgkmcnt(8)
    v_mfma_f32_32x32x16_bf16 v[24:39], v[88:91], v[224:227], v[24:39]
    ds_read_b64_tr_b16 v[108:109], v5 offset:55296
    ds_read_b64_tr_b16 v[110:111], v5 offset:55808
    s_waitcnt lgkmcnt(8)
    v_mfma_f32_32x32x16_bf16 v[40:55], v[92:95], v[224:227], v[40:55]
    ds_read_b64_tr_b16 v[112:113], v6 offset:55296
    ds_read_b64_tr_b16 v[114:115], v6 offset:55808
    s_waitcnt lgkmcnt(8)
    v_mfma_f32_32x32x16_bf16 v[56:71], v[96:99], v[224:227], v[56:71]
    ds_read_b64_tr_b16 v[116:117], v7 offset:55296
    ds_read_b64_tr_b16 v[118:119], v7 offset:55808
    s_waitcnt lgkmcnt(8)
    v_mfma_f32_32x32x16_bf16 v[72:87], v[100:103], v[224:227], v[72:87]
    s_waitcnt vmcnt(12)
    ds_read_b64_tr_b16 v[88:89], v4 offset:57344
    ds_read_b64_tr_b16 v[90:91], v4 offset:57856
    s_waitcnt lgkmcnt(8)
    v_mfma_f32_32x32x16_bf16 v[24:39], v[104:107], v[228:231], v[24:39]
    ds_read_b64_tr_b16 v[92:93], v5 offset:57344
    ds_read_b64_tr_b16 v[94:95], v5 offset:57856
    s_waitcnt lgkmcnt(8)
    v_mfma_f32_32x32x16_bf16 v[40:55], v[108:111], v[228:231], v[40:55]
    ds_read_b64_tr_b16 v[96:97], v6 offset:57344
    ds_read_b64_tr_b16 v[98:99], v6 offset:57856
    s_waitcnt lgkmcnt(8)
    v_mfma_f32_32x32x16_bf16 v[56:71], v[112:115], v[228:231], v[56:71]
    ds_read_b64_tr_b16 v[100:101], v7 offset:57344
    ds_read_b64_tr_b16 v[102:103], v7 offset:57856
    s_waitcnt lgkmcnt(8)
    v_mfma_f32_32x32x16_bf16 v[72:87], v[116:119], v[228:231], v[72:87]
    s_waitcnt vmcnt(11)
    ds_read_b64_tr_b16 v[104:105], v4 offset:59392
    ds_read_b64_tr_b16 v[106:107], v4 offset:59904
    s_waitcnt lgkmcnt(8)
    v_mfma_f32_32x32x16_bf16 v[24:39], v[88:91], v[232:235], v[24:39]
    ds_read_b64_tr_b16 v[108:109], v5 offset:59392
    ds_read_b64_tr_b16 v[110:111], v5 offset:59904
    s_waitcnt lgkmcnt(8)
    v_mfma_f32_32x32x16_bf16 v[40:55], v[92:95], v[232:235], v[40:55]
    ds_read_b64_tr_b16 v[112:113], v6 offset:59392
    ds_read_b64_tr_b16 v[114:115], v6 offset:59904
    s_waitcnt lgkmcnt(8)
    v_mfma_f32_32x32x16_bf16 v[56:71], v[96:99], v[232:235], v[56:71]
    ds_read_b64_tr_b16 v[116:117], v7 offset:59392
    ds_read_b64_tr_b16 v[118:119], v7 offset:59904
    s_waitcnt lgkmcnt(8)
    v_mfma_f32_32x32x16_bf16 v[72:87], v[100:103], v[232:235], v[72:87]
    s_waitcnt vmcnt(10)
    ds_read_b64_tr_b16 v[88:89], v4 offset:61440
    ds_read_b64_tr_b16 v[90:91], v4 offset:61952
    s_waitcnt lgkmcnt(8)
    v_mfma_f32_32x32x16_bf16 v[24:39], v[104:107], v[236:239], v[24:39]
    ds_read_b64_tr_b16 v[92:93], v5 offset:61440
    ds_read_b64_tr_b16 v[94:95], v5 offset:61952
    s_waitcnt lgkmcnt(8)
    v_mfma_f32_32x32x16_bf16 v[40:55], v[108:111], v[236:239], v[40:55]
    ds_read_b64_tr_b16 v[96:97], v6 offset:61440
    ds_read_b64_tr_b16 v[98:99], v6 offset:61952
    s_waitcnt lgkmcnt(8)
    v_mfma_f32_32x32x16_bf16 v[56:71], v[112:115], v[236:239], v[56:71]
    ds_read_b64_tr_b16 v[100:101], v7 offset:61440
    ds_read_b64_tr_b16 v[102:103], v7 offset:61952
    s_waitcnt lgkmcnt(8)
    v_mfma_f32_32x32x16_bf16 v[72:87], v[116:119], v[236:239], v[72:87]
    s_waitcnt vmcnt(9)
    ds_read_b64_tr_b16 v[104:105], v4 offset:63488
    ds_read_b64_tr_b16 v[106:107], v4 offset:64000
    s_waitcnt lgkmcnt(8)
    v_mfma_f32_32x32x16_bf16 v[24:39], v[88:91], v[240:243], v[24:39]
    ds_read_b64_tr_b16 v[108:109], v5 offset:63488
    ds_read_b64_tr_b16 v[110:111], v5 offset:64000
    s_waitcnt lgkmcnt(8)
    v_mfma_f32_32x32x16_bf16 v[40:55], v[92:95], v[240:243], v[40:55]
    ds_read_b64_tr_b16 v[112:113], v6 offset:63488
    ds_read_b64_tr_b16 v[114:115], v6 offset:64000
    s_waitcnt lgkmcnt(8)
    v_mfma_f32_32x32x16_bf16 v[56:71], v[96:99], v[240:243], v[56:71]
    ds_read_b64_tr_b16 v[116:117], v7 offset:63488
    ds_read_b64_tr_b16 v[118:119], v7 offset:64000
    s_waitcnt lgkmcnt(8)
    v_mfma_f32_32x32x16_bf16 v[72:87], v[100:103], v[240:243], v[72:87]
    s_waitcnt vmcnt(0)
    v_add_f32 v16, v16, v20
    v_add_f32 v17, v17, v21
    v_add_f32 v18, v18, v22
    v_add_f32 v19, v19, v23
    v_add_f32 v16, v16, v18
    v_add_f32 v17, v17, v19
    v_add_f32 v16, v16, v17
    v_mov_b32 v17, v16
    s_nop 1
    v_permlane32_swap_b32 v16, v17
    s_nop 0
    v_mul_f32 v16, 0x3b000000, v16
    v_mul_f32 v17, 0x3b000000, v17
    v_fma_f32 v17, -v16, v16, v17
    v_max_f32 v17, 0, v17
    v_add_f32 v17, 0x3727c5ac, v17
    v_rsq_f32 v17, v17
    s_nop 0
    v_mul_f32 v14, 0xbfb8aa3b, v17
    v_mul_f32 v15, v14, v16
    v_sub_f32 v15, 0, v15
    v_mov_b32 v2, 0xbfb8aa3b
    s_waitcnt lgkmcnt(6)
    v_mfma_f32_32x32x16_bf16 v[24:39], v[104:107], v[244:247], v[24:39]
    s_waitcnt lgkmcnt(4)
    v_mfma_f32_32x32x16_bf16 v[40:55], v[108:111], v[244:247], v[40:55]
    s_waitcnt lgkmcnt(2)
    v_mfma_f32_32x32x16_bf16 v[56:71], v[112:115], v[244:247], v[56:71]
    s_waitcnt lgkmcnt(0)
    v_mfma_f32_32x32x16_bf16 v[72:87], v[116:119], v[244:247], v[72:87]
    v_lshrrev_b32 v9, 5, v1
    v_lshlrev_b32 v9, 4, v9
    v_add_u32 v9, 0x20000, v9
    s_barrier
    ds_read_b128 v[120:123], v9 offset:0
    ds_read_b128 v[124:127], v9 offset:32
    ds_read_b128 v[128:131], v9 offset:64
    ds_read_b128 v[132:135], v9 offset:96
    ds_read_b128 v[136:139], v9 offset:128
    ds_read_b128 v[140:143], v9 offset:160
    ds_read_b128 v[144:147], v9 offset:192
    ds_read_b128 v[148:151], v9 offset:224
    ds_read_b128 v[152:155], v9 offset:256
    ds_read_b128 v[156:159], v9 offset:288
    ds_read_b128 v[160:163], v9 offset:320
    ds_read_b128 v[164:167], v9 offset:352
    ds_read_b128 v[168:171], v9 offset:384
    ds_read_b128 v[172:175], v9 offset:416
    ds_read_b128 v[176:179], v9 offset:448
    ds_read_b128 v[180:183], v9 offset:480
    v_pk_mul_f32 v[24:25], v[24:25], v[14:15] op_sel_hi:[1,0]
    v_pk_mul_f32 v[26:27], v[26:27], v[14:15] op_sel_hi:[1,0]
    v_pk_mul_f32 v[28:29], v[28:29], v[14:15] op_sel_hi:[1,0]
    v_pk_mul_f32 v[30:31], v[30:31], v[14:15] op_sel_hi:[1,0]
    v_pk_mul_f32 v[32:33], v[32:33], v[14:15] op_sel_hi:[1,0]
    v_pk_mul_f32 v[34:35], v[34:35], v[14:15] op_sel_hi:[1,0]
    v_pk_mul_f32 v[36:37], v[36:37], v[14:15] op_sel_hi:[1,0]
    v_pk_mul_f32 v[38:39], v[38:39], v[14:15] op_sel_hi:[1,0]
    v_pk_mul_f32 v[40:41], v[40:41], v[14:15] op_sel_hi:[1,0]
    v_pk_mul_f32 v[42:43], v[42:43], v[14:15] op_sel_hi:[1,0]
    v_pk_mul_f32 v[44:45], v[44:45], v[14:15] op_sel_hi:[1,0]
    v_pk_mul_f32 v[46:47], v[46:47], v[14:15] op_sel_hi:[1,0]
    v_pk_mul_f32 v[48:49], v[48:49], v[14:15] op_sel_hi:[1,0]
    v_pk_mul_f32 v[50:51], v[50:51], v[14:15] op_sel_hi:[1,0]
    v_pk_mul_f32 v[52:53], v[52:53], v[14:15] op_sel_hi:[1,0]
    v_pk_mul_f32 v[54:55], v[54:55], v[14:15] op_sel_hi:[1,0]
    v_pk_mul_f32 v[56:57], v[56:57], v[14:15] op_sel_hi:[1,0]
    v_pk_mul_f32 v[58:59], v[58:59], v[14:15] op_sel_hi:[1,0]
    v_pk_mul_f32 v[60:61], v[60:61], v[14:15] op_sel_hi:[1,0]
    v_pk_mul_f32 v[62:63], v[62:63], v[14:15] op_sel_hi:[1,0]
    v_pk_mul_f32 v[64:65], v[64:65], v[14:15] op_sel_hi:[1,0]
    v_pk_mul_f32 v[66:67], v[66:67], v[14:15] op_sel_hi:[1,0]
    v_pk_mul_f32 v[68:69], v[68:69], v[14:15] op_sel_hi:[1,0]
    v_pk_mul_f32 v[70:71], v[70:71], v[14:15] op_sel_hi:[1,0]
    v_pk_mul_f32 v[72:73], v[72:73], v[14:15] op_sel_hi:[1,0]
    v_pk_mul_f32 v[74:75], v[74:75], v[14:15] op_sel_hi:[1,0]
    v_pk_mul_f32 v[76:77], v[76:77], v[14:15] op_sel_hi:[1,0]
    v_pk_mul_f32 v[78:79], v[78:79], v[14:15] op_sel_hi:[1,0]
    v_pk_mul_f32 v[80:81], v[80:81], v[14:15] op_sel_hi:[1,0]
    v_pk_mul_f32 v[82:83], v[82:83], v[14:15] op_sel_hi:[1,0]
    v_pk_mul_f32 v[84:85], v[84:85], v[14:15] op_sel_hi:[1,0]
    v_pk_mul_f32 v[86:87], v[86:87], v[14:15] op_sel_hi:[1,0]
    s_waitcnt lgkmcnt(0)
    s_barrier
    v_pk_fma_f32 v[24:25], v[120:121], v[14:15], v[24:25] op_sel:[0,1,0] op_sel_hi:[1,1,1]
    v_pk_fma_f32 v[26:27], v[122:123], v[14:15], v[26:27] op_sel:[0,1,0] op_sel_hi:[1,1,1]
    v_pk_fma_f32 v[28:29], v[124:125], v[14:15], v[28:29] op_sel:[0,1,0] op_sel_hi:[1,1,1]
    v_pk_fma_f32 v[30:31], v[126:127], v[14:15], v[30:31] op_sel:[0,1,0] op_sel_hi:[1,1,1]
    v_exp_f32 v88, v24
    v_exp_f32 v89, v25
    v_exp_f32 v90, v26
    v_exp_f32 v91, v27
    v_exp_f32 v92, v28
    v_exp_f32 v93, v29
    v_exp_f32 v94, v30
    v_exp_f32 v95, v31
    s_nop 0
    v_pk_fma_f32 v[88:89], v[88:89], v[2:3], v[2:3] op_sel_hi:[1,0,0]
    v_pk_fma_f32 v[90:91], v[90:91], v[2:3], v[2:3] op_sel_hi:[1,0,0]
    v_pk_fma_f32 v[92:93], v[92:93], v[2:3], v[2:3] op_sel_hi:[1,0,0]
    v_pk_fma_f32 v[94:95], v[94:95], v[2:3], v[2:3] op_sel_hi:[1,0,0]
    v_rcp_f32 v88, v88
    v_rcp_f32 v89, v89
    v_rcp_f32 v90, v90
    v_rcp_f32 v91, v91
    v_rcp_f32 v92, v92
    v_rcp_f32 v93, v93
    v_rcp_f32 v94, v94
    v_rcp_f32 v95, v95
    s_nop 0
    v_pk_mul_f32 v[24:25], v[24:25], v[88:89]
    v_pk_mul_f32 v[26:27], v[26:27], v[90:91]
    v_pk_mul_f32 v[28:29], v[28:29], v[92:93]
    v_pk_mul_f32 v[30:31], v[30:31], v[94:95]
    v_cvt_pk_bf16_f32 v184, v24, v25
    v_cvt_pk_bf16_f32 v185, v26, v27
    v_cvt_pk_bf16_f32 v186, v28, v29
    v_cvt_pk_bf16_f32 v187, v30, v31
    s_cmp_eq_u32 s54, 0
    s_cbranch_scc1 gs_69
    buffer_store_dwordx4 v[184:187], v13, s[28:31], 0 offen offset:0
    s_branch gd_70
gs_69:
    buffer_store_dwordx4 v[184:187], v13, s[28:31], 0 offen offset:0 sc1
gd_70:
    v_pk_fma_f32 v[32:33], v[128:129], v[14:15], v[32:33] op_sel:[0,1,0] op_sel_hi:[1,1,1]
    v_pk_fma_f32 v[34:35], v[130:131], v[14:15], v[34:35] op_sel:[0,1,0] op_sel_hi:[1,1,1]
    v_pk_fma_f32 v[36:37], v[132:133], v[14:15], v[36:37] op_sel:[0,1,0] op_sel_hi:[1,1,1]
    v_pk_fma_f32 v[38:39], v[134:135], v[14:15], v[38:39] op_sel:[0,1,0] op_sel_hi:[1,1,1]
    v_exp_f32 v88, v32
    v_exp_f32 v89, v33
    v_exp_f32 v90, v34
    v_exp_f32 v91, v35
    v_exp_f32 v92, v36
    v_exp_f32 v93, v37
    v_exp_f32 v94, v38
    v_exp_f32 v95, v39
    s_nop 0
    v_pk_fma_f32 v[88:89], v[88:89], v[2:3], v[2:3] op_sel_hi:[1,0,0]
    v_pk_fma_f32 v[90:91], v[90:91], v[2:3], v[2:3] op_sel_hi:[1,0,0]
    v_pk_fma_f32 v[92:93], v[92:93], v[2:3], v[2:3] op_sel_hi:[1,0,0]
    v_pk_fma_f32 v[94:95], v[94:95], v[2:3], v[2:3] op_sel_hi:[1,0,0]
    v_rcp_f32 v88, v88
    v_rcp_f32 v89, v89
    v_rcp_f32 v90, v90
    v_rcp_f32 v91, v91
    v_rcp_f32 v92, v92
    v_rcp_f32 v93, v93
    v_rcp_f32 v94, v94
    v_rcp_f32 v95, v95
    s_nop 0
    v_pk_mul_f32 v[32:33], v[32:33], v[88:89]
    v_pk_mul_f32 v[34:35], v[34:35], v[90:91]
    v_pk_mul_f32 v[36:37], v[36:37], v[92:93]
    v_pk_mul_f32 v[38:39], v[38:39], v[94:95]
    v_cvt_pk_bf16_f32 v188, v32, v33
    v_cvt_pk_bf16_f32 v189, v34, v35
    v_cvt_pk_bf16_f32 v190, v36, v37
    v_cvt_pk_bf16_f32 v191, v38, v39
    s_cmp_eq_u32 s54, 0
    s_cbranch_scc1 gs_71
    buffer_store_dwordx4 v[188:191], v13, s[28:31], 0 offen offset:1024
    s_branch gd_72
gs_71:
    buffer_store_dwordx4 v[188:191], v13, s[28:31], 0 offen offset:1024 sc1
gd_72:
    v_pk_fma_f32 v[40:41], v[136:137], v[14:15], v[40:41] op_sel:[0,1,0] op_sel_hi:[1,1,1]
    v_pk_fma_f32 v[42:43], v[138:139], v[14:15], v[42:43] op_sel:[0,1,0] op_sel_hi:[1,1,1]
    v_pk_fma_f32 v[44:45], v[140:141], v[14:15], v[44:45] op_sel:[0,1,0] op_sel_hi:[1,1,1]
    v_pk_fma_f32 v[46:47], v[142:143], v[14:15], v[46:47] op_sel:[0,1,0] op_sel_hi:[1,1,1]
    v_exp_f32 v88, v40
    v_exp_f32 v89, v41
    v_exp_f32 v90, v42
    v_exp_f32 v91, v43
    v_exp_f32 v92, v44
    v_exp_f32 v93, v45
    v_exp_f32 v94, v46
    v_exp_f32 v95, v47
    s_nop 0
    v_pk_fma_f32 v[88:89], v[88:89], v[2:3], v[2:3] op_sel_hi:[1,0,0]
    v_pk_fma_f32 v[90:91], v[90:91], v[2:3], v[2:3] op_sel_hi:[1,0,0]
    v_pk_fma_f32 v[92:93], v[92:93], v[2:3], v[2:3] op_sel_hi:[1,0,0]
    v_pk_fma_f32 v[94:95], v[94:95], v[2:3], v[2:3] op_sel_hi:[1,0,0]
    v_rcp_f32 v88, v88
    v_rcp_f32 v89, v89
    v_rcp_f32 v90, v90
    v_rcp_f32 v91, v91
    v_rcp_f32 v92, v92
    v_rcp_f32 v93, v93
    v_rcp_f32 v94, v94
    v_rcp_f32 v95, v95
    s_nop 0
    v_pk_mul_f32 v[40:41], v[40:41], v[88:89]
    v_pk_mul_f32 v[42:43], v[42:43], v[90:91]
    v_pk_mul_f32 v[44:45], v[44:45], v[92:93]
    v_pk_mul_f32 v[46:47], v[46:47], v[94:95]
    v_cvt_pk_bf16_f32 v192, v40, v41
    v_cvt_pk_bf16_f32 v193, v42, v43
    v_cvt_pk_bf16_f32 v194, v44, v45
    v_cvt_pk_bf16_f32 v195, v46, v47
    s_cmp_eq_u32 s54, 0
    s_cbranch_scc1 gs_73
    buffer_store_dwordx4 v[192:195], v13, s[28:31], 0 offen offset:2048
    s_branch gd_74
gs_73:
    buffer_store_dwordx4 v[192:195], v13, s[28:31], 0 offen offset:2048 sc1
gd_74:
    v_pk_fma_f32 v[48:49], v[144:145], v[14:15], v[48:49] op_sel:[0,1,0] op_sel_hi:[1,1,1]
    v_pk_fma_f32 v[50:51], v[146:147], v[14:15], v[50:51] op_sel:[0,1,0] op_sel_hi:[1,1,1]
    v_pk_fma_f32 v[52:53], v[148:149], v[14:15], v[52:53] op_sel:[0,1,0] op_sel_hi:[1,1,1]
    v_pk_fma_f32 v[54:55], v[150:151], v[14:15], v[54:55] op_sel:[0,1,0] op_sel_hi:[1,1,1]
    v_exp_f32 v88, v48
    v_exp_f32 v89, v49
    v_exp_f32 v90, v50
    v_exp_f32 v91, v51
    v_exp_f32 v92, v52
    v_exp_f32 v93, v53
    v_exp_f32 v94, v54
    v_exp_f32 v95, v55
    s_nop 0
    v_pk_fma_f32 v[88:89], v[88:89], v[2:3], v[2:3] op_sel_hi:[1,0,0]
    v_pk_fma_f32 v[90:91], v[90:91], v[2:3], v[2:3] op_sel_hi:[1,0,0]
    v_pk_fma_f32 v[92:93], v[92:93], v[2:3], v[2:3] op_sel_hi:[1,0,0]
    v_pk_fma_f32 v[94:95], v[94:95], v[2:3], v[2:3] op_sel_hi:[1,0,0]
    v_rcp_f32 v88, v88
    v_rcp_f32 v89, v89
    v_rcp_f32 v90, v90
    v_rcp_f32 v91, v91
    v_rcp_f32 v92, v92
    v_rcp_f32 v93, v93
    v_rcp_f32 v94, v94
    v_rcp_f32 v95, v95
    s_nop 0
    v_pk_mul_f32 v[48:49], v[48:49], v[88:89]
    v_pk_mul_f32 v[50:51], v[50:51], v[90:91]
    v_pk_mul_f32 v[52:53], v[52:53], v[92:93]
    v_pk_mul_f32 v[54:55], v[54:55], v[94:95]
    v_cvt_pk_bf16_f32 v196, v48, v49
    v_cvt_pk_bf16_f32 v197, v50, v51
    v_cvt_pk_bf16_f32 v198, v52, v53
    v_cvt_pk_bf16_f32 v199, v54, v55
    s_cmp_eq_u32 s54, 0
    s_cbranch_scc1 gs_75
    buffer_store_dwordx4 v[196:199], v13, s[28:31], 0 offen offset:3072
    s_branch gd_76
gs_75:
    buffer_store_dwordx4 v[196:199], v13, s[28:31], 0 offen offset:3072 sc1
gd_76:
    v_pk_fma_f32 v[56:57], v[152:153], v[14:15], v[56:57] op_sel:[0,1,0] op_sel_hi:[1,1,1]
    v_pk_fma_f32 v[58:59], v[154:155], v[14:15], v[58:59] op_sel:[0,1,0] op_sel_hi:[1,1,1]
    v_pk_fma_f32 v[60:61], v[156:157], v[14:15], v[60:61] op_sel:[0,1,0] op_sel_hi:[1,1,1]
    v_pk_fma_f32 v[62:63], v[158:159], v[14:15], v[62:63] op_sel:[0,1,0] op_sel_hi:[1,1,1]
    v_exp_f32 v88, v56
    v_exp_f32 v89, v57
    v_exp_f32 v90, v58
    v_exp_f32 v91, v59
    v_exp_f32 v92, v60
    v_exp_f32 v93, v61
    v_exp_f32 v94, v62
    v_exp_f32 v95, v63
    s_nop 0
    v_pk_fma_f32 v[88:89], v[88:89], v[2:3], v[2:3] op_sel_hi:[1,0,0]
    v_pk_fma_f32 v[90:91], v[90:91], v[2:3], v[2:3] op_sel_hi:[1,0,0]
    v_pk_fma_f32 v[92:93], v[92:93], v[2:3], v[2:3] op_sel_hi:[1,0,0]
    v_pk_fma_f32 v[94:95], v[94:95], v[2:3], v[2:3] op_sel_hi:[1,0,0]
    v_rcp_f32 v88, v88
    v_rcp_f32 v89, v89
    v_rcp_f32 v90, v90
    v_rcp_f32 v91, v91
    v_rcp_f32 v92, v92
    v_rcp_f32 v93, v93
    v_rcp_f32 v94, v94
    v_rcp_f32 v95, v95
    s_nop 0
    v_pk_mul_f32 v[56:57], v[56:57], v[88:89]
    v_pk_mul_f32 v[58:59], v[58:59], v[90:91]
    v_pk_mul_f32 v[60:61], v[60:61], v[92:93]
    v_pk_mul_f32 v[62:63], v[62:63], v[94:95]
    v_cvt_pk_bf16_f32 v200, v56, v57
    v_cvt_pk_bf16_f32 v201, v58, v59
    v_cvt_pk_bf16_f32 v202, v60, v61
    v_cvt_pk_bf16_f32 v203, v62, v63
    s_movk_i32 s8, 0x1000
    s_cmp_eq_u32 s54, 0
    s_cbranch_scc1 gs_77
    buffer_store_dwordx4 v[200:203], v13, s[28:31], s8 offen offset:0
    s_branch gd_78
gs_77:
    buffer_store_dwordx4 v[200:203], v13, s[28:31], s8 offen offset:0 sc1
gd_78:
    v_pk_fma_f32 v[64:65], v[160:161], v[14:15], v[64:65] op_sel:[0,1,0] op_sel_hi:[1,1,1]
    v_pk_fma_f32 v[66:67], v[162:163], v[14:15], v[66:67] op_sel:[0,1,0] op_sel_hi:[1,1,1]
    v_pk_fma_f32 v[68:69], v[164:165], v[14:15], v[68:69] op_sel:[0,1,0] op_sel_hi:[1,1,1]
    v_pk_fma_f32 v[70:71], v[166:167], v[14:15], v[70:71] op_sel:[0,1,0] op_sel_hi:[1,1,1]
    v_exp_f32 v88, v64
    v_exp_f32 v89, v65
    v_exp_f32 v90, v66
    v_exp_f32 v91, v67
    v_exp_f32 v92, v68
    v_exp_f32 v93, v69
    v_exp_f32 v94, v70
    v_exp_f32 v95, v71
    s_nop 0
    v_pk_fma_f32 v[88:89], v[88:89], v[2:3], v[2:3] op_sel_hi:[1,0,0]
    v_pk_fma_f32 v[90:91], v[90:91], v[2:3], v[2:3] op_sel_hi:[1,0,0]
    v_pk_fma_f32 v[92:93], v[92:93], v[2:3], v[2:3] op_sel_hi:[1,0,0]
    v_pk_fma_f32 v[94:95], v[94:95], v[2:3], v[2:3] op_sel_hi:[1,0,0]
    v_rcp_f32 v88, v88
    v_rcp_f32 v89, v89
    v_rcp_f32 v90, v90
    v_rcp_f32 v91, v91
    v_rcp_f32 v92, v92
    v_rcp_f32 v93, v93
    v_rcp_f32 v94, v94
    v_rcp_f32 v95, v95
    s_nop 0
    v_pk_mul_f32 v[64:65], v[64:65], v[88:89]
    v_pk_mul_f32 v[66:67], v[66:67], v[90:91]
    v_pk_mul_f32 v[68:69], v[68:69], v[92:93]
    v_pk_mul_f32 v[70:71], v[70:71], v[94:95]
    v_cvt_pk_bf16_f32 v204, v64, v65
    v_cvt_pk_bf16_f32 v205, v66, v67
    v_cvt_pk_bf16_f32 v206, v68, v69
    v_cvt_pk_bf16_f32 v207, v70, v71
    s_cmp_eq_u32 s54, 0
    s_cbranch_scc1 gs_79
    buffer_store_dwordx4 v[204:207], v13, s[28:31], s8 offen offset:1024
    s_branch gd_80
gs_79:
    buffer_store_dwordx4 v[204:207], v13, s[28:31], s8 offen offset:1024 sc1
gd_80:
    v_pk_fma_f32 v[72:73], v[168:169], v[14:15], v[72:73] op_sel:[0,1,0] op_sel_hi:[1,1,1]
    v_pk_fma_f32 v[74:75], v[170:171], v[14:15], v[74:75] op_sel:[0,1,0] op_sel_hi:[1,1,1]
    v_pk_fma_f32 v[76:77], v[172:173], v[14:15], v[76:77] op_sel:[0,1,0] op_sel_hi:[1,1,1]
    v_pk_fma_f32 v[78:79], v[174:175], v[14:15], v[78:79] op_sel:[0,1,0] op_sel_hi:[1,1,1]
    v_exp_f32 v88, v72
    v_exp_f32 v89, v73
    v_exp_f32 v90, v74
    v_exp_f32 v91, v75
    v_exp_f32 v92, v76
    v_exp_f32 v93, v77
    v_exp_f32 v94, v78
    v_exp_f32 v95, v79
    s_nop 0
    v_pk_fma_f32 v[88:89], v[88:89], v[2:3], v[2:3] op_sel_hi:[1,0,0]
    v_pk_fma_f32 v[90:91], v[90:91], v[2:3], v[2:3] op_sel_hi:[1,0,0]
    v_pk_fma_f32 v[92:93], v[92:93], v[2:3], v[2:3] op_sel_hi:[1,0,0]
    v_pk_fma_f32 v[94:95], v[94:95], v[2:3], v[2:3] op_sel_hi:[1,0,0]
    v_rcp_f32 v88, v88
    v_rcp_f32 v89, v89
    v_rcp_f32 v90, v90
    v_rcp_f32 v91, v91
    v_rcp_f32 v92, v92
    v_rcp_f32 v93, v93
    v_rcp_f32 v94, v94
    v_rcp_f32 v95, v95
    s_nop 0
    v_pk_mul_f32 v[72:73], v[72:73], v[88:89]
    v_pk_mul_f32 v[74:75], v[74:75], v[90:91]
    v_pk_mul_f32 v[76:77], v[76:77], v[92:93]
    v_pk_mul_f32 v[78:79], v[78:79], v[94:95]
    v_cvt_pk_bf16_f32 v208, v72, v73
    v_cvt_pk_bf16_f32 v209, v74, v75
    v_cvt_pk_bf16_f32 v210, v76, v77
    v_cvt_pk_bf16_f32 v211, v78, v79
    s_cmp_eq_u32 s54, 0
    s_cbranch_scc1 gs_81
    buffer_store_dwordx4 v[208:211], v13, s[28:31], s8 offen offset:2048
    s_branch gd_82
gs_81:
    buffer_store_dwordx4 v[208:211], v13, s[28:31], s8 offen offset:2048 sc1
gd_82:
    v_pk_fma_f32 v[80:81], v[176:177], v[14:15], v[80:81] op_sel:[0,1,0] op_sel_hi:[1,1,1]
    v_pk_fma_f32 v[82:83], v[178:179], v[14:15], v[82:83] op_sel:[0,1,0] op_sel_hi:[1,1,1]
    v_pk_fma_f32 v[84:85], v[180:181], v[14:15], v[84:85] op_sel:[0,1,0] op_sel_hi:[1,1,1]
    v_pk_fma_f32 v[86:87], v[182:183], v[14:15], v[86:87] op_sel:[0,1,0] op_sel_hi:[1,1,1]
    v_exp_f32 v88, v80
    v_exp_f32 v89, v81
    v_exp_f32 v90, v82
    v_exp_f32 v91, v83
    v_exp_f32 v92, v84
    v_exp_f32 v93, v85
    v_exp_f32 v94, v86
    v_exp_f32 v95, v87
    s_nop 0
    v_pk_fma_f32 v[88:89], v[88:89], v[2:3], v[2:3] op_sel_hi:[1,0,0]
    v_pk_fma_f32 v[90:91], v[90:91], v[2:3], v[2:3] op_sel_hi:[1,0,0]
    v_pk_fma_f32 v[92:93], v[92:93], v[2:3], v[2:3] op_sel_hi:[1,0,0]
    v_pk_fma_f32 v[94:95], v[94:95], v[2:3], v[2:3] op_sel_hi:[1,0,0]
    v_rcp_f32 v88, v88
    v_rcp_f32 v89, v89
    v_rcp_f32 v90, v90
    v_rcp_f32 v91, v91
    v_rcp_f32 v92, v92
    v_rcp_f32 v93, v93
    v_rcp_f32 v94, v94
    v_rcp_f32 v95, v95
    s_nop 0
    v_pk_mul_f32 v[80:81], v[80:81], v[88:89]
    v_pk_mul_f32 v[82:83], v[82:83], v[90:91]
    v_pk_mul_f32 v[84:85], v[84:85], v[92:93]
    v_pk_mul_f32 v[86:87], v[86:87], v[94:95]
    v_cvt_pk_bf16_f32 v212, v80, v81
    v_cvt_pk_bf16_f32 v213, v82, v83
    v_cvt_pk_bf16_f32 v214, v84, v85
    v_cvt_pk_bf16_f32 v215, v86, v87
    s_cmp_eq_u32 s54, 0
    s_cbranch_scc1 gs_83
    buffer_store_dwordx4 v[212:215], v13, s[28:31], s8 offen offset:3072
    s_branch gd_84
gs_83:
    buffer_store_dwordx4 v[212:215], v13, s[28:31], s8 offen offset:3072 sc1
gd_84:
    s_branch p3fin_63
p3ld_62:
    s_setprio 0
    v_lshrrev_b32 v9, 3, v1
    s_mov_b32 s6, 3584
    v_mul_lo_u32 v2, v9, s6
    v_bfe_u32 v9, v1, 4, 1
    v_lshlrev_b32 v9, 2, v9
    v_and_b32 v10, 7, v1
    v_xor_b32 v9, v9, v10
    v_lshl_add_u32 v2, v9, 4, v2
    s_and_b32 s57, s56, 1
    s_lshr_b32 s58, s56, 1
    s_mul_i32 s6, s58, 114688
    s_lshl_b32 s7, s57, 7
    s_add_u32 s6, s6, s7
    s_lshl_b32 s7, s11, 8
    s_add_u32 s6, s6, s7
    v_add_u32 v2, s6, v2
    v_xor_b32 v3, 32, v2
    s_lshl_b32 s14, s57, 16
    s_lshl_b32 s7, s58, 12
    s_add_u32 s14, s14, s7
    s_add_u32 m0, s14, 0x0
    s_nop 0
    buffer_load_dwordx4 v2, s[20:23], 0 offen lds
    s_add_u32 m0, s14, 0x400
    s_mov_b32 s9, 0x7000
    buffer_load_dwordx4 v3, s[20:23], s9 offen lds
    s_add_u32 m0, s14, 0x800
    s_mov_b32 s9, 0xe000
    buffer_load_dwordx4 v2, s[20:23], s9 offen lds
    s_add_u32 m0, s14, 0xc00
    s_mov_b32 s9, 0x15000
    buffer_load_dwordx4 v3, s[20:23], s9 offen lds
    s_add_u32 m0, s14, 0x2000
    s_mov_b32 s9, 0x38000
    buffer_load_dwordx4 v2, s[20:23], s9 offen lds
    s_add_u32 m0, s14, 0x2400
    s_mov_b32 s9, 0x3f000
    buffer_load_dwordx4 v3, s[20:23], s9 offen lds
    s_add_u32 m0, s14, 0x2800
    s_mov_b32 s9, 0x46000
    buffer_load_dwordx4 v2, s[20:23], s9 offen lds
    s_add_u32 m0, s14, 0x2c00
    s_mov_b32 s9, 0x4d000
    buffer_load_dwordx4 v3, s[20:23], s9 offen lds
    s_add_u32 m0, s14, 0x4000
    s_mov_b32 s9, 0x70000
    buffer_load_dwordx4 v2, s[20:23], s9 offen lds
    s_add_u32 m0, s14, 0x4400
    s_mov_b32 s9, 0x77000
    buffer_load_dwordx4 v3, s[20:23], s9 offen lds
    s_add_u32 m0, s14, 0x4800
    s_mov_b32 s9, 0x7e000
    buffer_load_dwordx4 v2, s[20:23], s9 offen lds
    s_add_u32 m0, s14, 0x4c00
    s_mov_b32 s9, 0x85000
    buffer_load_dwordx4 v3, s[20:23], s9 offen lds
    v_bfe_u32 v9, v1, 2, 2
    v_lshrrev_b32 v10, 5, v1
    v_lshl_add_u32 v4, v10, 3, v9
    v_lshlrev_b32 v4, 7, v4
    v_lshrrev_b32 v9, 1, v9
    v_lshlrev_b32 v9, 2, v9
    v_lshl_or_b32 v9, v10, 1, v9
    v_bfe_u32 v10, v1, 4, 1
    v_and_b32 v11, 1, v1
    v_lshl_or_b32 v10, v10, 1, v11
    v_bfe_u32 v11, v1, 1, 1
    v_xor_b32 v9, v9, v10
    v_lshl_add_u32 v4, v9, 4, v4
    v_lshl_add_u32 v4, v11, 3, v4
    s_lshl_b32 s6, s57, 6
    v_xor_b32 v4, s6, v4
    s_lshl_b32 s6, s58, 16
    v_add_u32 v4, s6, v4
    v_mov_b32 v5, 0
    v_mov_b32 v6, 0
    s_barrier
    s_waitcnt vmcnt(8)
    s_barrier
    s_add_u32 m0, s14, 0x6000
    s_mov_b32 s9, 0xa8000
    buffer_load_dwordx4 v2, s[20:23], s9 offen lds
    s_add_u32 m0, s14, 0x6400
    s_mov_b32 s9, 0xaf000
    buffer_load_dwordx4 v3, s[20:23], s9 offen lds
    s_add_u32 m0, s14, 0x6800
    s_mov_b32 s9, 0xb6000
    buffer_load_dwordx4 v2, s[20:23], s9 offen lds
    s_add_u32 m0, s14, 0x6c00
    s_mov_b32 s9, 0xbd000
    buffer_load_dwordx4 v3, s[20:23], s9 offen lds
    s_add_u32 m0, s14, 0x8000
    s_mov_b32 s9, 0xe0000
    buffer_load_dwordx4 v2, s[20:23], s9 offen lds
    s_add_u32 m0, s14, 0x8400
    s_mov_b32 s9, 0xe7000
    buffer_load_dwordx4 v3, s[20:23], s9 offen lds
    s_add_u32 m0, s14, 0x8800
    s_mov_b32 s9, 0xee000
    buffer_load_dwordx4 v2, s[20:23], s9 offen lds
    s_add_u32 m0, s14, 0x8c00
    s_mov_b32 s9, 0xf5000
    buffer_load_dwordx4 v3, s[20:23], s9 offen lds
    s_cmp_lg_u32 s100, 0
    s_cbranch_scc1 ifl_85
    ds_read_b64_tr_b16 v[16:17], v4 offset:0
    ds_read_b64_tr_b16 v[18:19], v4 offset:512
    ds_read_b64_tr_b16 v[20:21], v4 offset:2048
    ds_read_b64_tr_b16 v[22:23], v4 offset:2560
    ds_read_b64_tr_b16 v[24:25], v4 offset:4096
    ds_read_b64_tr_b16 v[26:27], v4 offset:4608
    ds_read_b64_tr_b16 v[28:29], v4 offset:6144
    ds_read_b64_tr_b16 v[30:31], v4 offset:6656
    s_waitcnt lgkmcnt(6)
    v_dot2_f32_bf16 v5, v16, s15, v5
    v_dot2_f32_bf16 v6, v17, s15, v6
    v_dot2_f32_bf16 v5, v18, s15, v5
    v_dot2_f32_bf16 v6, v19, s15, v6
    s_waitcnt lgkmcnt(4)
    v_dot2_f32_bf16 v5, v20, s15, v5
    v_dot2_f32_bf16 v6, v21, s15, v6
    v_dot2_f32_bf16 v5, v22, s15, v5
    v_dot2_f32_bf16 v6, v23, s15, v6
    s_waitcnt lgkmcnt(2)
    v_dot2_f32_bf16 v5, v24, s15, v5
    v_dot2_f32_bf16 v6, v25, s15, v6
    v_dot2_f32_bf16 v5, v26, s15, v5
    v_dot2_f32_bf16 v6, v27, s15, v6
    s_waitcnt lgkmcnt(0)
    v_dot2_f32_bf16 v5, v28, s15, v5
    v_dot2_f32_bf16 v6, v29, s15, v6
    v_dot2_f32_bf16 v5, v30, s15, v5
    v_dot2_f32_bf16 v6, v31, s15, v6
ifl_85:
    s_waitcnt vmcnt(12)
    s_barrier
    s_add_u32 m0, s14, 0xa000
    s_mov_b32 s9, 0x118000
    buffer_load_dwordx4 v2, s[20:23], s9 offen lds
    s_add_u32 m0, s14, 0xa400
    s_mov_b32 s9, 0x11f000
    buffer_load_dwordx4 v3, s[20:23], s9 offen lds
    s_add_u32 m0, s14, 0xa800
    s_mov_b32 s9, 0x126000
    buffer_load_dwordx4 v2, s[20:23], s9 offen lds
    s_add_u32 m0, s14, 0xac00
    s_mov_b32 s9, 0x12d000
    buffer_load_dwordx4 v3, s[20:23], s9 offen lds
    s_add_u32 m0, s14, 0xc000
    s_mov_b32 s9, 0x150000
    buffer_load_dwordx4 v2, s[20:23], s9 offen lds
    s_add_u32 m0, s14, 0xc400
    s_mov_b32 s9, 0x157000
    buffer_load_dwordx4 v3, s[20:23], s9 offen lds
    s_add_u32 m0, s14, 0xc800
    s_mov_b32 s9, 0x15e000
    buffer_load_dwordx4 v2, s[20:23], s9 offen lds
    s_add_u32 m0, s14, 0xcc00
    s_mov_b32 s9, 0x165000
    buffer_load_dwordx4 v3, s[20:23], s9 offen lds
    s_cmp_lg_u32 s100, 0
    s_cbranch_scc1 ifl_86
    ds_read_b64_tr_b16 v[16:17], v4 offset:8192
    ds_read_b64_tr_b16 v[18:19], v4 offset:8704
    ds_read_b64_tr_b16 v[20:21], v4 offset:10240
    ds_read_b64_tr_b16 v[22:23], v4 offset:10752
    ds_read_b64_tr_b16 v[24:25], v4 offset:12288
    ds_read_b64_tr_b16 v[26:27], v4 offset:12800
    ds_read_b64_tr_b16 v[28:29], v4 offset:14336
    ds_read_b64_tr_b16 v[30:31], v4 offset:14848
    s_waitcnt lgkmcnt(6)
    v_dot2_f32_bf16 v5, v16, s15, v5
    v_dot2_f32_bf16 v6, v17, s15, v6
    v_dot2_f32_bf16 v5, v18, s15, v5
    v_dot2_f32_bf16 v6, v19, s15, v6
    s_waitcnt lgkmcnt(4)
    v_dot2_f32_bf16 v5, v20, s15, v5
    v_dot2_f32_bf16 v6, v21, s15, v6
    v_dot2_f32_bf16 v5, v22, s15, v5
    v_dot2_f32_bf16 v6, v23, s15, v6
    s_waitcnt lgkmcnt(2)
    v_dot2_f32_bf16 v5, v24, s15, v5
    v_dot2_f32_bf16 v6, v25, s15, v6
    v_dot2_f32_bf16 v5, v26, s15, v5
    v_dot2_f32_bf16 v6, v27, s15, v6
    s_waitcnt lgkmcnt(0)
    v_dot2_f32_bf16 v5, v28, s15, v5
    v_dot2_f32_bf16 v6, v29, s15, v6
    v_dot2_f32_bf16 v5, v30, s15, v5
    v_dot2_f32_bf16 v6, v31, s15, v6
ifl_86:
    s_waitcnt vmcnt(16)
    s_barrier
    s_add_u32 m0, s14, 0xe000
    s_mov_b32 s9, 0x188000
    buffer_load_dwordx4 v2, s[20:23], s9 offen lds
    s_add_u32 m0, s14, 0xe400
    s_mov_b32 s9, 0x18f000
    buffer_load_dwordx4 v3, s[20:23], s9 offen lds
    s_add_u32 m0, s14, 0xe800
    s_mov_b32 s9, 0x196000
    buffer_load_dwordx4 v2, s[20:23], s9 offen lds
    s_add_u32 m0, s14, 0xec00
    s_mov_b32 s9, 0x19d000
    buffer_load_dwordx4 v3, s[20:23], s9 offen lds
    s_cmp_lg_u32 s100, 0
    s_cbranch_scc1 ifl_87
    ds_read_b64_tr_b16 v[16:17], v4 offset:16384
    ds_read_b64_tr_b16 v[18:19], v4 offset:16896
    ds_read_b64_tr_b16 v[20:21], v4 offset:18432
    ds_read_b64_tr_b16 v[22:23], v4 offset:18944
    ds_read_b64_tr_b16 v[24:25], v4 offset:20480
    ds_read_b64_tr_b16 v[26:27], v4 offset:20992
    ds_read_b64_tr_b16 v[28:29], v4 offset:22528
    ds_read_b64_tr_b16 v[30:31], v4 offset:23040
    s_waitcnt lgkmcnt(6)
    v_dot2_f32_bf16 v5, v16, s15, v5
    v_dot2_f32_bf16 v6, v17, s15, v6
    v_dot2_f32_bf16 v5, v18, s15, v5
    v_dot2_f32_bf16 v6, v19, s15, v6
    s_waitcnt lgkmcnt(4)
    v_dot2_f32_bf16 v5, v20, s15, v5
    v_dot2_f32_bf16 v6, v21, s15, v6
    v_dot2_f32_bf16 v5, v22, s15, v5
    v_dot2_f32_bf16 v6, v23, s15, v6
    s_waitcnt lgkmcnt(2)
    v_dot2_f32_bf16 v5, v24, s15, v5
    v_dot2_f32_bf16 v6, v25, s15, v6
    v_dot2_f32_bf16 v5, v26, s15, v5
    v_dot2_f32_bf16 v6, v27, s15, v6
    s_waitcnt lgkmcnt(0)
    v_dot2_f32_bf16 v5, v28, s15, v5
    v_dot2_f32_bf16 v6, v29, s15, v6
    v_dot2_f32_bf16 v5, v30, s15, v5
    v_dot2_f32_bf16 v6, v31, s15, v6
ifl_87:
    s_waitcnt vmcnt(16)
    s_barrier
    s_lshl_b32 s6, s10, 2
    s_add_u32 s6, s6, s56
    s_mul_i32 s6, s6, 114688
    s_lshl_b32 s7, s11, 13
    s_add_u32 s6, s6, s7
    v_lshl_add_u32 v7, v1, 7, s6
    buffer_load_dword v242, v7, s[28:31], 0 offen sc1
    s_cmp_lg_u32 s100, 0
    s_cbranch_scc1 ifl_88
    ds_read_b64_tr_b16 v[16:17], v4 offset:24576
    ds_read_b64_tr_b16 v[18:19], v4 offset:25088
    ds_read_b64_tr_b16 v[20:21], v4 offset:26624
    ds_read_b64_tr_b16 v[22:23], v4 offset:27136
    ds_read_b64_tr_b16 v[24:25], v4 offset:28672
    ds_read_b64_tr_b16 v[26:27], v4 offset:29184
    ds_read_b64_tr_b16 v[28:29], v4 offset:30720
    ds_read_b64_tr_b16 v[30:31], v4 offset:31232
    s_waitcnt lgkmcnt(6)
    v_dot2_f32_bf16 v5, v16, s15, v5
    v_dot2_f32_bf16 v6, v17, s15, v6
    v_dot2_f32_bf16 v5, v18, s15, v5
    v_dot2_f32_bf16 v6, v19, s15, v6
    s_waitcnt lgkmcnt(4)
    v_dot2_f32_bf16 v5, v20, s15, v5
    v_dot2_f32_bf16 v6, v21, s15, v6
    v_dot2_f32_bf16 v5, v22, s15, v5
    v_dot2_f32_bf16 v6, v23, s15, v6
    s_waitcnt lgkmcnt(2)
    v_dot2_f32_bf16 v5, v24, s15, v5
    v_dot2_f32_bf16 v6, v25, s15, v6
    v_dot2_f32_bf16 v5, v26, s15, v5
    v_dot2_f32_bf16 v6, v27, s15, v6
    s_waitcnt lgkmcnt(0)
    v_dot2_f32_bf16 v5, v28, s15, v5
    v_dot2_f32_bf16 v6, v29, s15, v6
    v_dot2_f32_bf16 v5, v30, s15, v5
    v_dot2_f32_bf16 v6, v31, s15, v6
ifl_88:
    s_waitcnt vmcnt(1)
    s_barrier
    s_mov_b32 s24, s46
    s_mov_b32 s25, s47
    s_mov_b32 s26, 0x1c0000
    s_mov_b32 s27, 0x20000
    s_mov_b32 s6, 0
    s_mul_i32 s7, s56, 458752
    s_add_u32 s6, s6, s7
    s_mul_i32 s7, s5, 5120
    s_add_u32 s6, s6, s7
    v_min_u32 v7, 39, v1
    v_lshl_add_u32 v7, v7, 7, s6
    buffer_load_dword v240, v7, s[24:27], 0 offen
    s_mov_b32 s24, s46
    s_mov_b32 s25, s47
    s_mov_b32 s26, 0x1c0000
    s_mov_b32 s27, 0x20000
    s_mov_b32 s6, 163840
    s_mul_i32 s7, s56, 458752
    s_add_u32 s6, s6, s7
    s_mul_i32 s7, s5, 9216
    s_add_u32 s6, s6, s7
    v_min_u32 v7, 63, v1
    v_lshl_add_u32 v7, v7, 7, s6
    buffer_load_dword v240, v7, s[24:27], 0 offen
    v_min_u32 v7, 7, v1
    v_lshl_add_u32 v7, v7, 7, s6
    v_add_u32 v7, 8192, v7
    buffer_load_dword v240, v7, s[24:27], 0 offen
    s_cmp_lg_u32 s100, 0
    s_cbranch_scc1 ifl_89
    s_lshr_b32 s6, s5, 3
    s_lshl_b32 s7, s4, 2
    s_add_u32 s6, s6, s7
    s_lshl_b32 s6, s6, 16
    s_mul_i32 s7, s56, 16384
    s_add_u32 s6, s6, s7
    s_and_b32 s7, s5, 7
    s_lshl_b32 s7, s7, 7
    s_add_u32 s6, s6, s7
    s_add_u32 s24, s52, 0xc00000
    s_addc_u32 s25, s53, 0
    s_mov_b32 s26, 0x200000
    s_mov_b32 s27, 0x20000
    v_and_b32 v7, 15, v1
    v_lshl_add_u32 v7, v7, 10, s6
    buffer_load_dword v242, v7, s[24:27], 0 offen sc1
ifl_89:
    s_cmp_lg_u32 s100, 0
    s_cbranch_scc1 ifl_90
    ds_read_b64_tr_b16 v[16:17], v4 offset:32768
    ds_read_b64_tr_b16 v[18:19], v4 offset:33280
    ds_read_b64_tr_b16 v[20:21], v4 offset:34816
    ds_read_b64_tr_b16 v[22:23], v4 offset:35328
    ds_read_b64_tr_b16 v[24:25], v4 offset:36864
    ds_read_b64_tr_b16 v[26:27], v4 offset:37376
    ds_read_b64_tr_b16 v[28:29], v4 offset:38912
    ds_read_b64_tr_b16 v[30:31], v4 offset:39424
    s_waitcnt lgkmcnt(6)
    v_dot2_f32_bf16 v5, v16, s15, v5
    v_dot2_f32_bf16 v6, v17, s15, v6
    v_dot2_f32_bf16 v5, v18, s15, v5
    v_dot2_f32_bf16 v6, v19, s15, v6
    s_waitcnt lgkmcnt(4)
    v_dot2_f32_bf16 v5, v20, s15, v5
    v_dot2_f32_bf16 v6, v21, s15, v6
    v_dot2_f32_bf16 v5, v22, s15, v5
    v_dot2_f32_bf16 v6, v23, s15, v6
    s_waitcnt lgkmcnt(2)
    v_dot2_f32_bf16 v5, v24, s15, v5
    v_dot2_f32_bf16 v6, v25, s15, v6
    v_dot2_f32_bf16 v5, v26, s15, v5
    v_dot2_f32_bf16 v6, v27, s15, v6
    s_waitcnt lgkmcnt(0)
    v_dot2_f32_bf16 v5, v28, s15, v5
    v_dot2_f32_bf16 v6, v29, s15, v6
    v_dot2_f32_bf16 v5, v30, s15, v5
    v_dot2_f32_bf16 v6, v31, s15, v6
ifl_90:
    s_cmp_lg_u32 s100, 0
    s_cbranch_scc1 ifl_91
    ds_read_b64_tr_b16 v[16:17], v4 offset:40960
    ds_read_b64_tr_b16 v[18:19], v4 offset:41472
    ds_read_b64_tr_b16 v[20:21], v4 offset:43008
    ds_read_b64_tr_b16 v[22:23], v4 offset:43520
    ds_read_b64_tr_b16 v[24:25], v4 offset:45056
    ds_read_b64_tr_b16 v[26:27], v4 offset:45568
    ds_read_b64_tr_b16 v[28:29], v4 offset:47104
    ds_read_b64_tr_b16 v[30:31], v4 offset:47616
    s_waitcnt lgkmcnt(6)
    v_dot2_f32_bf16 v5, v16, s15, v5
    v_dot2_f32_bf16 v6, v17, s15, v6
    v_dot2_f32_bf16 v5, v18, s15, v5
    v_dot2_f32_bf16 v6, v19, s15, v6
    s_waitcnt lgkmcnt(4)
    v_dot2_f32_bf16 v5, v20, s15, v5
    v_dot2_f32_bf16 v6, v21, s15, v6
    v_dot2_f32_bf16 v5, v22, s15, v5
    v_dot2_f32_bf16 v6, v23, s15, v6
    s_waitcnt lgkmcnt(2)
    v_dot2_f32_bf16 v5, v24, s15, v5
    v_dot2_f32_bf16 v6, v25, s15, v6
    v_dot2_f32_bf16 v5, v26, s15, v5
    v_dot2_f32_bf16 v6, v27, s15, v6
    s_waitcnt lgkmcnt(0)
    v_dot2_f32_bf16 v5, v28, s15, v5
    v_dot2_f32_bf16 v6, v29, s15, v6
    v_dot2_f32_bf16 v5, v30, s15, v5
    v_dot2_f32_bf16 v6, v31, s15, v6
ifl_91:
    s_cmp_lg_u32 s100, 0
    s_cbranch_scc1 ifl_92
    ds_read_b64_tr_b16 v[16:17], v4 offset:49152
    ds_read_b64_tr_b16 v[18:19], v4 offset:49664
    ds_read_b64_tr_b16 v[20:21], v4 offset:51200
    ds_read_b64_tr_b16 v[22:23], v4 offset:51712
    ds_read_b64_tr_b16 v[24:25], v4 offset:53248
    ds_read_b64_tr_b16 v[26:27], v4 offset:53760
    ds_read_b64_tr_b16 v[28:29], v4 offset:55296
    ds_read_b64_tr_b16 v[30:31], v4 offset:55808
    s_waitcnt lgkmcnt(6)
    v_dot2_f32_bf16 v5, v16, s15, v5
    v_dot2_f32_bf16 v6, v17, s15, v6
    v_dot2_f32_bf16 v5, v18, s15, v5
    v_dot2_f32_bf16 v6, v19, s15, v6
    s_waitcnt lgkmcnt(4)
    v_dot2_f32_bf16 v5, v20, s15, v5
    v_dot2_f32_bf16 v6, v21, s15, v6
    v_dot2_f32_bf16 v5, v22, s15, v5
    v_dot2_f32_bf16 v6, v23, s15, v6
    s_waitcnt lgkmcnt(2)
    v_dot2_f32_bf16 v5, v24, s15, v5
    v_dot2_f32_bf16 v6, v25, s15, v6
    v_dot2_f32_bf16 v5, v26, s15, v5
    v_dot2_f32_bf16 v6, v27, s15, v6
    s_waitcnt lgkmcnt(0)
    v_dot2_f32_bf16 v5, v28, s15, v5
    v_dot2_f32_bf16 v6, v29, s15, v6
    v_dot2_f32_bf16 v5, v30, s15, v5
    v_dot2_f32_bf16 v6, v31, s15, v6
ifl_92:
    s_cmp_lg_u32 s100, 0
    s_cbranch_scc1 ifl_93
    ds_read_b64_tr_b16 v[16:17], v4 offset:57344
    ds_read_b64_tr_b16 v[18:19], v4 offset:57856
    ds_read_b64_tr_b16 v[20:21], v4 offset:59392
    ds_read_b64_tr_b16 v[22:23], v4 offset:59904
    ds_read_b64_tr_b16 v[24:25], v4 offset:61440
    ds_read_b64_tr_b16 v[26:27], v4 offset:61952
    ds_read_b64_tr_b16 v[28:29], v4 offset:63488
    ds_read_b64_tr_b16 v[30:31], v4 offset:64000
    s_waitcnt lgkmcnt(6)
    v_dot2_f32_bf16 v5, v16, s15, v5
    v_dot2_f32_bf16 v6, v17, s15, v6
    v_dot2_f32_bf16 v5, v18, s15, v5
    v_dot2_f32_bf16 v6, v19, s15, v6
    s_waitcnt lgkmcnt(4)
    v_dot2_f32_bf16 v5, v20, s15, v5
    v_dot2_f32_bf16 v6, v21, s15, v6
    v_dot2_f32_bf16 v5, v22, s15, v5
    v_dot2_f32_bf16 v6, v23, s15, v6
    s_waitcnt lgkmcnt(2)
    v_dot2_f32_bf16 v5, v24, s15, v5
    v_dot2_f32_bf16 v6, v25, s15, v6
    v_dot2_f32_bf16 v5, v26, s15, v5
    v_dot2_f32_bf16 v6, v27, s15, v6
    s_waitcnt lgkmcnt(0)
    v_dot2_f32_bf16 v5, v28, s15, v5
    v_dot2_f32_bf16 v6, v29, s15, v6
    v_dot2_f32_bf16 v5, v30, s15, v5
    v_dot2_f32_bf16 v6, v31, s15, v6
ifl_93:
    s_lshl_b32 s6, s56, 7
    s_add_u32 s6, s6, 0x20000
    v_and_b32 v9, 31, v1
    v_lshl_add_u32 v9, v9, 2, s6
    s_nop 1
    s_cmp_lg_u32 s100, 0
    s_cbranch_scc1 ifl_94
    v_add_f32 v5, v5, v6
    v_mov_b32 v6, v5
    s_nop 1
    v_permlane32_swap_b32 v6, v5
    s_nop 0
    v_add_f32 v5, v5, v6
    v_mov_b32 v252, v5
ifl_94:
    ds_write_b32 v9, v252
    s_waitcnt lgkmcnt(0)
    s_setprio 0
    s_barrier
    s_barrier
    s_mov_b32 s20, s46
    s_mov_b32 s21, s47
    s_mov_b32 s22, 0x1c0000
    s_mov_b32 s23, 0x20000
    v_lshrrev_b32 v9, 3, v1
    s_mov_b32 s6, 1024
    v_mul_lo_u32 v14, v9, s6
    v_bfe_u32 v9, v1, 4, 1
    v_lshlrev_b32 v9, 2, v9
    v_and_b32 v10, 7, v1
    v_xor_b32 v9, v9, v10
    v_lshl_add_u32 v14, v9, 4, v14
    s_mul_i32 s6, s56, 458752
    s_and_b32 s7, s5, 7
    s_lshl_b32 s7, s7, 7
    s_add_u32 s6, s6, s7
    s_mul_i32 s14, s56, 40960
    s_add_u32 s14, s14, 0
    v_add_u32 v14, s6, v14
    v_xor_b32 v15, 32, v14
    v_add_u32 v15, 0x2000, v15
    s_add_u32 m0, s14, 0x0
    s_nop 0
    buffer_load_dwordx4 v14, s[20:23], 0 offen lds
    s_add_u32 m0, s14, 0x400
    s_nop 0
    buffer_load_dwordx4 v15, s[20:23], 0 offen lds
    s_add_u32 m0, s14, 0x800
    s_mov_b32 s9, 0x4000
    buffer_load_dwordx4 v14, s[20:23], s9 offen lds
    s_add_u32 m0, s14, 0xc00
    s_mov_b32 s9, 0x4000
    buffer_load_dwordx4 v15, s[20:23], s9 offen lds
    s_add_u32 m0, s14, 0x1000
    s_mov_b32 s9, 0x8000
    buffer_load_dwordx4 v14, s[20:23], s9 offen lds
    s_add_u32 m0, s14, 0x1400
    s_mov_b32 s9, 0x8000
    buffer_load_dwordx4 v15, s[20:23], s9 offen lds
    s_add_u32 m0, s14, 0x1800
    s_mov_b32 s9, 0xc000
    buffer_load_dwordx4 v14, s[20:23], s9 offen lds
    s_add_u32 m0, s14, 0x1c00
    s_mov_b32 s9, 0xc000
    buffer_load_dwordx4 v15, s[20:23], s9 offen lds
    s_add_u32 m0, s14, 0x2000
    s_mov_b32 s9, 0x10000
    buffer_load_dwordx4 v14, s[20:23], s9 offen lds
    s_add_u32 m0, s14, 0x2400
    s_mov_b32 s9, 0x10000
    buffer_load_dwordx4 v15, s[20:23], s9 offen lds
    s_add_u32 m0, s14, 0x2800
    s_mov_b32 s9, 0x14000
    buffer_load_dwordx4 v14, s[20:23], s9 offen lds
    s_add_u32 m0, s14, 0x2c00
    s_mov_b32 s9, 0x14000
    buffer_load_dwordx4 v15, s[20:23], s9 offen lds
    s_add_u32 m0, s14, 0x3000
    s_mov_b32 s9, 0x18000
    buffer_load_dwordx4 v14, s[20:23], s9 offen lds
    s_add_u32 m0, s14, 0x3400
    s_mov_b32 s9, 0x18000
    buffer_load_dwordx4 v15, s[20:23], s9 offen lds
    s_add_u32 m0, s14, 0x3800
    s_mov_b32 s9, 0x1c000
    buffer_load_dwordx4 v14, s[20:23], s9 offen lds
    s_add_u32 m0, s14, 0x3c00
    s_mov_b32 s9, 0x1c000
    buffer_load_dwordx4 v15, s[20:23], s9 offen lds
    s_add_u32 m0, s14, 0x4000
    s_mov_b32 s9, 0x20000
    buffer_load_dwordx4 v14, s[20:23], s9 offen lds
    s_add_u32 m0, s14, 0x4400
    s_mov_b32 s9, 0x20000
    buffer_load_dwordx4 v15, s[20:23], s9 offen lds
    s_add_u32 m0, s14, 0x4800
    s_mov_b32 s9, 0x24000
    buffer_load_dwordx4 v14, s[20:23], s9 offen lds
    s_add_u32 m0, s14, 0x4c00
    s_mov_b32 s9, 0x24000
    buffer_load_dwordx4 v15, s[20:23], s9 offen lds
    s_add_u32 m0, s14, 0x5000
    s_mov_b32 s9, 0x28000
    buffer_load_dwordx4 v14, s[20:23], s9 offen lds
    s_add_u32 m0, s14, 0x5400
    s_mov_b32 s9, 0x28000
    buffer_load_dwordx4 v15, s[20:23], s9 offen lds
    s_add_u32 m0, s14, 0x5800
    s_mov_b32 s9, 0x2c000
    buffer_load_dwordx4 v14, s[20:23], s9 offen lds
    s_add_u32 m0, s14, 0x5c00
    s_mov_b32 s9, 0x2c000
    buffer_load_dwordx4 v15, s[20:23], s9 offen lds
    s_add_u32 m0, s14, 0x6000
    s_mov_b32 s9, 0x30000
    buffer_load_dwordx4 v14, s[20:23], s9 offen lds
    s_add_u32 m0, s14, 0x6400
    s_mov_b32 s9, 0x30000
    buffer_load_dwordx4 v15, s[20:23], s9 offen lds
    s_add_u32 m0, s14, 0x6800
    s_mov_b32 s9, 0x34000
    buffer_load_dwordx4 v14, s[20:23], s9 offen lds
    s_add_u32 m0, s14, 0x6c00
    s_mov_b32 s9, 0x34000
    buffer_load_dwordx4 v15, s[20:23], s9 offen lds
    s_add_u32 m0, s14, 0x7000
    s_mov_b32 s9, 0x38000
    buffer_load_dwordx4 v14, s[20:23], s9 offen lds
    s_add_u32 m0, s14, 0x7400
    s_mov_b32 s9, 0x38000
    buffer_load_dwordx4 v15, s[20:23], s9 offen lds
    s_add_u32 m0, s14, 0x7800
    s_mov_b32 s9, 0x3c000
    buffer_load_dwordx4 v14, s[20:23], s9 offen lds
    s_add_u32 m0, s14, 0x7c00
    s_mov_b32 s9, 0x3c000
    buffer_load_dwordx4 v15, s[20:23], s9 offen lds
    s_barrier
    s_waitcnt vmcnt(0)
    s_branch p3end_65
p3fin_63:
    s_setprio 0
    s_waitcnt vmcnt(0)
    s_barrier
    s_cmp_lg_u32 s3, 0
    s_cbranch_scc1 nopub_95
    s_lshl_b32 s6, s4, 7
    s_lshl_b32 s7, s5, 2
    s_add_u32 s6, s6, s7
    v_mov_b32 v2, s6
    v_mov_b32 v3, s55
    s_mov_b64 exec, 1
    s_add_u32 s8, s101, 2048
    s_cmp_eq_u32 s54, 0
    s_cbranch_scc1 gs_96
    buffer_store_dword v3, v2, s[96:99], s8 offen
    s_branch gd_97
gs_96:
    buffer_store_dword v3, v2, s[96:99], s8 offen sc1
gd_97:
    s_mov_b64 exec, -1
nopub_95:
    s_branch p3end_65
p3skip_64:
    s_cmp_lt_u32 s3, 4
    s_cbranch_scc1 p3np_98
    s_mov_b32 s24, s46
    s_mov_b32 s25, s47
    s_mov_b32 s26, 0x1c0000
    s_mov_b32 s27, 0x20000
    s_mov_b32 s6, 0
    s_mul_i32 s7, s56, 458752
    s_add_u32 s6, s6, s7
    s_mul_i32 s7, s5, 5120
    s_add_u32 s6, s6, s7
    v_min_u32 v7, 39, v1
    v_lshl_add_u32 v7, v7, 7, s6
    buffer_load_dword v240, v7, s[24:27], 0 offen
    s_mov_b32 s24, s46
    s_mov_b32 s25, s47
    s_mov_b32 s26, 0x1c0000
    s_mov_b32 s27, 0x20000
    s_mov_b32 s6, 163840
    s_mul_i32 s7, s56, 458752
    s_add_u32 s6, s6, s7
    s_mul_i32 s7, s5, 9216
    s_add_u32 s6, s6, s7
    v_min_u32 v7, 63, v1
    v_lshl_add_u32 v7, v7, 7, s6
    buffer_load_dword v240, v7, s[24:27], 0 offen
    v_min_u32 v7, 7, v1
    v_lshl_add_u32 v7, v7, 7, s6
    v_add_u32 v7, 8192, v7
    buffer_load_dword v240, v7, s[24:27], 0 offen
    s_cmp_lg_u32 s100, 0
    s_cbranch_scc1 ifl_99
    s_lshr_b32 s6, s5, 3
    s_lshl_b32 s7, s4, 2
    s_add_u32 s6, s6, s7
    s_lshl_b32 s6, s6, 16
    s_mul_i32 s7, s56, 16384
    s_add_u32 s6, s6, s7
    s_and_b32 s7, s5, 7
    s_lshl_b32 s7, s7, 7
    s_add_u32 s6, s6, s7
    s_add_u32 s24, s52, 0xc00000
    s_addc_u32 s25, s53, 0
    s_mov_b32 s26, 0x200000
    s_mov_b32 s27, 0x20000
    v_and_b32 v7, 15, v1
    v_lshl_add_u32 v7, v7, 10, s6
    buffer_load_dword v242, v7, s[24:27], 0 offen sc1
ifl_99:
    s_mov_b32 s20, s46
    s_mov_b32 s21, s47
    s_mov_b32 s22, 0x1c0000
    s_mov_b32 s23, 0x20000
    v_lshrrev_b32 v9, 3, v1
    s_mov_b32 s6, 1024
    v_mul_lo_u32 v14, v9, s6
    v_bfe_u32 v9, v1, 4, 1
    v_lshlrev_b32 v9, 2, v9
    v_and_b32 v10, 7, v1
    v_xor_b32 v9, v9, v10
    v_lshl_add_u32 v14, v9, 4, v14
    s_mul_i32 s6, s56, 458752
    s_and_b32 s7, s5, 7
    s_lshl_b32 s7, s7, 7
    s_add_u32 s6, s6, s7
    s_mul_i32 s14, s56, 40960
    s_add_u32 s14, s14, 0
    v_add_u32 v14, s6, v14
    v_xor_b32 v15, 32, v14
    v_add_u32 v15, 0x2000, v15
    s_add_u32 m0, s14, 0x0
    s_nop 0
    buffer_load_dwordx4 v14, s[20:23], 0 offen lds
    s_add_u32 m0, s14, 0x400
    s_nop 0
    buffer_load_dwordx4 v15, s[20:23], 0 offen lds
    s_add_u32 m0, s14, 0x800
    s_mov_b32 s9, 0x4000
    buffer_load_dwordx4 v14, s[20:23], s9 offen lds
    s_add_u32 m0, s14, 0xc00
    s_mov_b32 s9, 0x4000
    buffer_load_dwordx4 v15, s[20:23], s9 offen lds
    s_add_u32 m0, s14, 0x1000
    s_mov_b32 s9, 0x8000
    buffer_load_dwordx4 v14, s[20:23], s9 offen lds
    s_add_u32 m0, s14, 0x1400
    s_mov_b32 s9, 0x8000
    buffer_load_dwordx4 v15, s[20:23], s9 offen lds
    s_add_u32 m0, s14, 0x1800
    s_mov_b32 s9, 0xc000
    buffer_load_dwordx4 v14, s[20:23], s9 offen lds
    s_add_u32 m0, s14, 0x1c00
    s_mov_b32 s9, 0xc000
    buffer_load_dwordx4 v15, s[20:23], s9 offen lds
    s_add_u32 m0, s14, 0x2000
    s_mov_b32 s9, 0x10000
    buffer_load_dwordx4 v14, s[20:23], s9 offen lds
    s_add_u32 m0, s14, 0x2400
    s_mov_b32 s9, 0x10000
    buffer_load_dwordx4 v15, s[20:23], s9 offen lds
    s_add_u32 m0, s14, 0x2800
    s_mov_b32 s9, 0x14000
    buffer_load_dwordx4 v14, s[20:23], s9 offen lds
    s_add_u32 m0, s14, 0x2c00
    s_mov_b32 s9, 0x14000
    buffer_load_dwordx4 v15, s[20:23], s9 offen lds
    s_add_u32 m0, s14, 0x3000
    s_mov_b32 s9, 0x18000
    buffer_load_dwordx4 v14, s[20:23], s9 offen lds
    s_add_u32 m0, s14, 0x3400
    s_mov_b32 s9, 0x18000
    buffer_load_dwordx4 v15, s[20:23], s9 offen lds
    s_add_u32 m0, s14, 0x3800
    s_mov_b32 s9, 0x1c000
    buffer_load_dwordx4 v14, s[20:23], s9 offen lds
    s_add_u32 m0, s14, 0x3c00
    s_mov_b32 s9, 0x1c000
    buffer_load_dwordx4 v15, s[20:23], s9 offen lds
    s_add_u32 m0, s14, 0x4000
    s_mov_b32 s9, 0x20000
    buffer_load_dwordx4 v14, s[20:23], s9 offen lds
    s_add_u32 m0, s14, 0x4400
    s_mov_b32 s9, 0x20000
    buffer_load_dwordx4 v15, s[20:23], s9 offen lds
    s_add_u32 m0, s14, 0x4800
    s_mov_b32 s9, 0x24000
    buffer_load_dwordx4 v14, s[20:23], s9 offen lds
    s_add_u32 m0, s14, 0x4c00
    s_mov_b32 s9, 0x24000
    buffer_load_dwordx4 v15, s[20:23], s9 offen lds
    s_add_u32 m0, s14, 0x5000
    s_mov_b32 s9, 0x28000
    buffer_load_dwordx4 v14, s[20:23], s9 offen lds
    s_add_u32 m0, s14, 0x5400
    s_mov_b32 s9, 0x28000
    buffer_load_dwordx4 v15, s[20:23], s9 offen lds
    s_add_u32 m0, s14, 0x5800
    s_mov_b32 s9, 0x2c000
    buffer_load_dwordx4 v14, s[20:23], s9 offen lds
    s_add_u32 m0, s14, 0x5c00
    s_mov_b32 s9, 0x2c000
    buffer_load_dwordx4 v15, s[20:23], s9 offen lds
    s_add_u32 m0, s14, 0x6000
    s_mov_b32 s9, 0x30000
    buffer_load_dwordx4 v14, s[20:23], s9 offen lds
    s_add_u32 m0, s14, 0x6400
    s_mov_b32 s9, 0x30000
    buffer_load_dwordx4 v15, s[20:23], s9 offen lds
    s_add_u32 m0, s14, 0x6800
    s_mov_b32 s9, 0x34000
    buffer_load_dwordx4 v14, s[20:23], s9 offen lds
    s_add_u32 m0, s14, 0x6c00
    s_mov_b32 s9, 0x34000
    buffer_load_dwordx4 v15, s[20:23], s9 offen lds
    s_add_u32 m0, s14, 0x7000
    s_mov_b32 s9, 0x38000
    buffer_load_dwordx4 v14, s[20:23], s9 offen lds
    s_add_u32 m0, s14, 0x7400
    s_mov_b32 s9, 0x38000
    buffer_load_dwordx4 v15, s[20:23], s9 offen lds
    s_add_u32 m0, s14, 0x7800
    s_mov_b32 s9, 0x3c000
    buffer_load_dwordx4 v14, s[20:23], s9 offen lds
    s_add_u32 m0, s14, 0x7c00
    s_mov_b32 s9, 0x3c000
    buffer_load_dwordx4 v15, s[20:23], s9 offen lds
p3np_98:
    s_waitcnt vmcnt(0)
    s_barrier
p3end_65:
    s_lshr_b32 s10, s5, 3
    s_lshl_b32 s6, s4, 2
    s_add_u32 s10, s10, s6
    s_and_b32 s11, s5, 7
    s_and_b32 s12, s3, 3
    s_lshr_b32 s13, s3, 2
    s_add_u32 s16, s52, 0x400000
    s_addc_u32 s17, s53, 0
    s_mov_b32 s18, 0x700000
    s_mov_b32 s19, 0x20000
    s_mov_b32 s20, s46
    s_mov_b32 s21, s47
    s_mov_b32 s22, 0x1c0000
    s_mov_b32 s23, 0x20000
    s_add_u32 s24, s52, 0xf00000
    s_addc_u32 s25, s53, 0
    s_mov_b32 s26, 0x20000
    s_mov_b32 s27, 0x20000
    s_mov_b32 s28, s48
    s_mov_b32 s29, s49
    s_mov_b32 s30, 0x200000
    s_mov_b32 s31, 0x20000
    s_cmp_lg_u32 s100, 0
    s_cbranch_scc1 ifl_100
    s_add_u32 s28, s52, 0xc00000
    s_addc_u32 s29, s53, 0
    s_mov_b32 s30, 0x200000
    s_mov_b32 s31, 0x20000
ifl_100:
    s_lshl_b32 s66, s10, 1
    s_add_u32 s66, s66, s13
    s_mul_i32 s6, s66, 114688
    s_mul_i32 s7, s12, 28672
    s_add_u32 s6, s6, s7
    v_lshl_add_u32 v12, v1, 4, s6
    v_lshrrev_b32 v9, 3, v1
    s_mov_b32 s6, 1024
    v_mul_lo_u32 v13, v9, s6
    v_bfe_u32 v9, v1, 4, 1
    v_lshlrev_b32 v9, 2, v9
    v_lshl_or_b32 v9, s13, 1, v9
    v_and_b32 v10, 7, v1
    v_xor_b32 v9, v9, v10
    v_lshl_add_u32 v13, v9, 4, v13
    s_mul_i32 s6, s12, 458752
    s_and_b32 s7, s5, 7
    s_lshl_b32 s7, s7, 7
    s_add_u32 s6, s6, s7
    s_mul_i32 s67, s12, 40960
    s_add_u32 s67, s67, 0
    s_lshl_b32 s7, s13, 13
    s_add_u32 s6, s6, s7
    s_lshl_b32 s7, s13, 10
    s_add_u32 s67, s67, s7
    v_add_u32 v13, s6, v13
    s_lshl_b32 s6, s66, 5
    s_lshl_b32 s7, s11, 2
    s_add_u32 s7, s7, s12
    s_add_u32 s6, s6, s7
    s_lshl_b32 s6, s6, 10
    v_lshl_add_u32 v4, v1, 4, s6
    s_lshl_b32 s6, s66, 15
    s_lshl_b32 s7, s7, 5
    s_add_u32 s6, s6, s7
    v_and_b32 v9, 31, v1
    v_lshlrev_b32 v9, 10, v9
    v_lshrrev_b32 v10, 5, v1
    v_lshl_add_u32 v9, v10, 4, v9
    v_add_u32 v5, s6, v9
    v_bfe_u32 v9, v1, 2, 2
    v_lshrrev_b32 v10, 5, v1
    v_lshl_add_u32 v6, v10, 3, v9
    v_lshlrev_b32 v6, 7, v6
    v_lshrrev_b32 v9, 1, v9
    v_lshlrev_b32 v9, 2, v9
    v_lshl_or_b32 v9, v10, 1, v9
    v_bfe_u32 v10, v1, 4, 1
    v_and_b32 v11, 1, v1
    v_lshl_or_b32 v10, v10, 1, v11
    v_bfe_u32 v11, v1, 1, 1
    v_xor_b32 v9, v9, v10
    v_lshl_add_u32 v6, v9, 4, v6
    v_lshl_add_u32 v6, v11, 3, v6
    s_mul_i32 s6, s12, 40960
    s_add_u32 s6, s6, 0
    v_add_u32 v6, s6, v6
    v_xor_b32 v7, 64, v6
    s_mul_i32 s6, s13, 24576
    s_add_u32 s6, s6, 114688
    v_lshl_add_u32 v8, v1, 4, s6
    s_add_u32 m0, s67, 0x8000
    s_mov_b32 s9, 0x40000
    buffer_load_dwordx4 v13, s[20:23], s9 offen lds
    s_add_u32 m0, s67, 0x8800
    s_mov_b32 s9, 0x44000
    buffer_load_dwordx4 v13, s[20:23], s9 offen lds
    s_add_u32 m0, s67, 0x9000
    s_mov_b32 s9, 0x48000
    buffer_load_dwordx4 v13, s[20:23], s9 offen lds
    s_add_u32 m0, s67, 0x9800
    s_mov_b32 s9, 0x4c000
    buffer_load_dwordx4 v13, s[20:23], s9 offen lds
    s_lshr_b32 s58, s5, 4
    s_mul_i32 s58, s58, 14
    s_cmp_lg_u32 s3, 0
    s_cbranch_scc1 nopoll_101
    s_lshl_b32 s6, s4, 7
    s_lshl_b32 s7, s58, 2
    s_add_u32 s6, s6, s7
    s_add_u32 s6, s6, 2048
    s_add_u32 s6, s6, s101
    v_min_u32 v2, 13, v1
    v_lshl_add_u32 v2, v2, 2, s6
    s_mov_b32 s9, 0
spin_102:
    buffer_load_dword v3, v2, s[96:99], 0 offen sc1
    s_waitcnt vmcnt(0)
    v_cmp_ne_u32 vcc, s55, v3
    s_add_u32 s9, s9, 1
    s_cmp_gt_u32 s9, 0x40000
    s_cbranch_scc1 spun_103
    s_cbranch_vccnz spin_102
spun_103:
    s_cmp_lg_u32 s54, 0
    s_cbranch_scc1 nopoll_101
    buffer_inv sc1
    s_waitcnt vmcnt(0)
nopoll_101:
    s_barrier
    buffer_load_dwordx4 v[80:83], v12, s[16:19], 0 offen offset:0 sc1
    buffer_load_dwordx4 v[84:87], v12, s[16:19], 0 offen offset:1024 sc1
    buffer_load_dwordx4 v[88:91], v12, s[16:19], 0 offen offset:2048 sc1
    buffer_load_dwordx4 v[92:95], v12, s[16:19], 0 offen offset:3072 sc1
    s_mov_b32 s8, 0x1000
    buffer_load_dwordx4 v[96:99], v12, s[16:19], s8 offen offset:0 sc1
    buffer_load_dwordx4 v[100:103], v12, s[16:19], s8 offen offset:1024 sc1
    buffer_load_dwordx4 v[104:107], v12, s[16:19], s8 offen offset:2048 sc1
    ds_read_b64_tr_b16 v[48:49], v6 offset:0
    ds_read_b64_tr_b16 v[50:51], v6 offset:512
    ds_read_b64_tr_b16 v[52:53], v7 offset:0
    ds_read_b64_tr_b16 v[54:55], v7 offset:512
    buffer_load_dwordx4 v[108:111], v12, s[16:19], s8 offen offset:3072 sc1
    s_waitcnt vmcnt(7)
    ds_read_b64_tr_b16 v[56:57], v6 offset:2048
    ds_read_b64_tr_b16 v[58:59], v6 offset:2560
    s_waitcnt lgkmcnt(4)
    v_mfma_f32_32x32x16_bf16 v[16:31], v[48:51], v[80:83], 0
    ds_read_b64_tr_b16 v[60:61], v7 offset:2048
    ds_read_b64_tr_b16 v[62:63], v7 offset:2560
    s_waitcnt lgkmcnt(4)
    v_mfma_f32_32x32x16_bf16 v[32:47], v[52:55], v[80:83], 0
    s_mov_b32 s8, 0x2000
    buffer_load_dwordx4 v[112:115], v12, s[16:19], s8 offen offset:0 sc1
    s_waitcnt vmcnt(7)
    ds_read_b64_tr_b16 v[48:49], v6 offset:4096
    ds_read_b64_tr_b16 v[50:51], v6 offset:4608
    s_waitcnt lgkmcnt(4)
    v_mfma_f32_32x32x16_bf16 v[16:31], v[56:59], v[84:87], v[16:31]
    ds_read_b64_tr_b16 v[52:53], v7 offset:4096
    ds_read_b64_tr_b16 v[54:55], v7 offset:4608
    s_waitcnt lgkmcnt(4)
    v_mfma_f32_32x32x16_bf16 v[32:47], v[60:63], v[84:87], v[32:47]
    buffer_load_dwordx4 v[116:119], v12, s[16:19], s8 offen offset:1024 sc1
    s_waitcnt vmcnt(7)
    ds_read_b64_tr_b16 v[56:57], v6 offset:6144
    ds_read_b64_tr_b16 v[58:59], v6 offset:6656
    s_waitcnt lgkmcnt(4)
    v_mfma_f32_32x32x16_bf16 v[16:31], v[48:51], v[88:91], v[16:31]
    ds_read_b64_tr_b16 v[60:61], v7 offset:6144
    ds_read_b64_tr_b16 v[62:63], v7 offset:6656
    s_waitcnt lgkmcnt(4)
    v_mfma_f32_32x32x16_bf16 v[32:47], v[52:55], v[88:91], v[32:47]
    buffer_load_dwordx4 v[120:123], v12, s[16:19], s8 offen offset:2048 sc1
    s_waitcnt vmcnt(7)
    ds_read_b64_tr_b16 v[48:49], v6 offset:8192
    ds_read_b64_tr_b16 v[50:51], v6 offset:8704
    s_waitcnt lgkmcnt(4)
    v_mfma_f32_32x32x16_bf16 v[16:31], v[56:59], v[92:95], v[16:31]
    ds_read_b64_tr_b16 v[52:53], v7 offset:8192
    ds_read_b64_tr_b16 v[54:55], v7 offset:8704
    s_waitcnt lgkmcnt(4)
    v_mfma_f32_32x32x16_bf16 v[32:47], v[60:63], v[92:95], v[32:47]
    buffer_load_dwordx4 v[124:127], v12, s[16:19], s8 offen offset:3072 sc1
    s_waitcnt vmcnt(7)
    ds_read_b64_tr_b16 v[56:57], v6 offset:10240
    ds_read_b64_tr_b16 v[58:59], v6 offset:10752
    s_waitcnt lgkmcnt(4)
    v_mfma_f32_32x32x16_bf16 v[16:31], v[48:51], v[96:99], v[16:31]
    ds_read_b64_tr_b16 v[60:61], v7 offset:10240
    ds_read_b64_tr_b16 v[62:63], v7 offset:10752
    s_waitcnt lgkmcnt(4)
    v_mfma_f32_32x32x16_bf16 v[32:47], v[52:55], v[96:99], v[32:47]
    s_mov_b32 s8, 0x3000
    buffer_load_dwordx4 v[128:131], v12, s[16:19], s8 offen offset:0 sc1
    s_waitcnt vmcnt(7)
    ds_read_b64_tr_b16 v[48:49], v6 offset:12288
    ds_read_b64_tr_b16 v[50:51], v6 offset:12800
    s_waitcnt lgkmcnt(4)
    v_mfma_f32_32x32x16_bf16 v[16:31], v[56:59], v[100:103], v[16:31]
    ds_read_b64_tr_b16 v[52:53], v7 offset:12288
    ds_read_b64_tr_b16 v[54:55], v7 offset:12800
    s_waitcnt lgkmcnt(4)
    v_mfma_f32_32x32x16_bf16 v[32:47], v[60:63], v[100:103], v[32:47]
    buffer_load_dwordx4 v[132:135], v12, s[16:19], s8 offen offset:1024 sc1
    s_waitcnt vmcnt(7)
    ds_read_b64_tr_b16 v[56:57], v6 offset:14336
    ds_read_b64_tr_b16 v[58:59], v6 offset:14848
    s_waitcnt lgkmcnt(4)
    v_mfma_f32_32x32x16_bf16 v[16:31], v[48:51], v[104:107], v[16:31]
    ds_read_b64_tr_b16 v[60:61], v7 offset:14336
    ds_read_b64_tr_b16 v[62:63], v7 offset:14848
    s_waitcnt lgkmcnt(4)
    v_mfma_f32_32x32x16_bf16 v[32:47], v[52:55], v[104:107], v[32:47]
    buffer_load_dwordx4 v[136:139], v12, s[16:19], s8 offen offset:2048 sc1
    s_waitcnt vmcnt(7)
    ds_read_b64_tr_b16 v[48:49], v6 offset:16384
    ds_read_b64_tr_b16 v[50:51], v6 offset:16896
    s_waitcnt lgkmcnt(4)
    v_mfma_f32_32x32x16_bf16 v[16:31], v[56:59], v[108:111], v[16:31]
    ds_read_b64_tr_b16 v[52:53], v7 offset:16384
    ds_read_b64_tr_b16 v[54:55], v7 offset:16896
    s_waitcnt lgkmcnt(4)
    v_mfma_f32_32x32x16_bf16 v[32:47], v[60:63], v[108:111], v[32:47]
    buffer_load_dwordx4 v[140:143], v12, s[16:19], s8 offen offset:3072 sc1
    s_waitcnt vmcnt(7)
    ds_read_b64_tr_b16 v[56:57], v6 offset:18432
    ds_read_b64_tr_b16 v[58:59], v6 offset:18944
    s_waitcnt lgkmcnt(4)
    v_mfma_f32_32x32x16_bf16 v[16:31], v[48:51], v[112:115], v[16:31]
    ds_read_b64_tr_b16 v[60:61], v7 offset:18432
    ds_read_b64_tr_b16 v[62:63], v7 offset:18944
    s_waitcnt lgkmcnt(4)
    v_mfma_f32_32x32x16_bf16 v[32:47], v[52:55], v[112:115], v[32:47]
    s_mov_b32 s8, 0x4000
    buffer_load_dwordx4 v[144:147], v12, s[16:19], s8 offen offset:0 sc1
    s_barrier
    s_add_u32 m0, s67, 0x0
    s_mov_b32 s9, 0x50000
    buffer_load_dwordx4 v13, s[20:23], s9 offen lds
    s_waitcnt vmcnt(8)
    ds_read_b64_tr_b16 v[48:49], v6 offset:20480
    ds_read_b64_tr_b16 v[50:51], v6 offset:20992
    s_waitcnt lgkmcnt(4)
    v_mfma_f32_32x32x16_bf16 v[16:31], v[56:59], v[116:119], v[16:31]
    ds_read_b64_tr_b16 v[52:53], v7 offset:20480
    ds_read_b64_tr_b16 v[54:55], v7 offset:20992
    s_waitcnt lgkmcnt(4)
    v_mfma_f32_32x32x16_bf16 v[32:47], v[60:63], v[116:119], v[32:47]
    buffer_load_dwordx4 v[148:151], v12, s[16:19], s8 offen offset:1024 sc1
    s_add_u32 m0, s67, 0x800
    s_mov_b32 s9, 0x54000
    buffer_load_dwordx4 v13, s[20:23], s9 offen lds
    s_waitcnt vmcnt(9)
    ds_read_b64_tr_b16 v[56:57], v6 offset:22528
    ds_read_b64_tr_b16 v[58:59], v6 offset:23040
    s_waitcnt lgkmcnt(4)
    v_mfma_f32_32x32x16_bf16 v[16:31], v[48:51], v[120:123], v[16:31]
    ds_read_b64_tr_b16 v[60:61], v7 offset:22528
    ds_read_b64_tr_b16 v[62:63], v7 offset:23040
    s_waitcnt lgkmcnt(4)
    v_mfma_f32_32x32x16_bf16 v[32:47], v[52:55], v[120:123], v[32:47]
    buffer_load_dwordx4 v[152:155], v12, s[16:19], s8 offen offset:2048 sc1
    s_add_u32 m0, s67, 0x1000
    s_mov_b32 s9, 0x58000
    buffer_load_dwordx4 v13, s[20:23], s9 offen lds
    s_waitcnt vmcnt(10)
    ds_read_b64_tr_b16 v[48:49], v6 offset:24576
    ds_read_b64_tr_b16 v[50:51], v6 offset:25088
    s_waitcnt lgkmcnt(4)
    v_mfma_f32_32x32x16_bf16 v[16:31], v[56:59], v[124:127], v[16:31]
    ds_read_b64_tr_b16 v[52:53], v7 offset:24576
    ds_read_b64_tr_b16 v[54:55], v7 offset:25088
    s_waitcnt lgkmcnt(4)
    v_mfma_f32_32x32x16_bf16 v[32:47], v[60:63], v[124:127], v[32:47]
    buffer_load_dwordx4 v[156:159], v12, s[16:19], s8 offen offset:3072 sc1
    s_add_u32 m0, s67, 0x1800
    s_mov_b32 s9, 0x5c000
    buffer_load_dwordx4 v13, s[20:23], s9 offen lds
    s_waitcnt vmcnt(11)
    ds_read_b64_tr_b16 v[56:57], v6 offset:26624
    ds_read_b64_tr_b16 v[58:59], v6 offset:27136
    s_waitcnt lgkmcnt(4)
    v_mfma_f32_32x32x16_bf16 v[16:31], v[48:51], v[128:131], v[16:31]
    ds_read_b64_tr_b16 v[60:61], v7 offset:26624
    ds_read_b64_tr_b16 v[62:63], v7 offset:27136
    s_waitcnt lgkmcnt(4)
    v_mfma_f32_32x32x16_bf16 v[32:47], v[52:55], v[128:131], v[32:47]
    s_mov_b32 s8, 0x5000
    buffer_load_dwordx4 v[160:163], v12, s[16:19], s8 offen offset:0 sc1
    s_add_u32 m0, s67, 0x2000
    s_mov_b32 s9, 0x60000
    buffer_load_dwordx4 v13, s[20:23], s9 offen lds
    s_waitcnt vmcnt(12)
    ds_read_b64_tr_b16 v[48:49], v6 offset:28672
    ds_read_b64_tr_b16 v[50:51], v6 offset:29184
    s_waitcnt lgkmcnt(4)
    v_mfma_f32_32x32x16_bf16 v[16:31], v[56:59], v[132:135], v[16:31]
    ds_read_b64_tr_b16 v[52:53], v7 offset:28672
    ds_read_b64_tr_b16 v[54:55], v7 offset:29184
    s_waitcnt lgkmcnt(4)
    v_mfma_f32_32x32x16_bf16 v[32:47], v[60:63], v[132:135], v[32:47]
    buffer_load_dwordx4 v[164:167], v12, s[16:19], s8 offen offset:1024 sc1
    s_add_u32 m0, s67, 0x2800
    s_mov_b32 s9, 0x64000
    buffer_load_dwordx4 v13, s[20:23], s9 offen lds
    s_waitcnt vmcnt(13)
    ds_read_b64_tr_b16 v[56:57], v6 offset:30720
    ds_read_b64_tr_b16 v[58:59], v6 offset:31232
    s_waitcnt lgkmcnt(4)
    v_mfma_f32_32x32x16_bf16 v[16:31], v[48:51], v[136:139], v[16:31]
    ds_read_b64_tr_b16 v[60:61], v7 offset:30720
    ds_read_b64_tr_b16 v[62:63], v7 offset:31232
    s_waitcnt lgkmcnt(4)
    v_mfma_f32_32x32x16_bf16 v[32:47], v[52:55], v[136:139], v[32:47]
    buffer_load_dwordx4 v[168:171], v12, s[16:19], s8 offen offset:2048 sc1
    s_add_u32 m0, s67, 0x3000
    s_mov_b32 s9, 0x68000
    buffer_load_dwordx4 v13, s[20:23], s9 offen lds
    s_waitcnt vmcnt(14)
    ds_read_b64_tr_b16 v[48:49], v6 offset:32768
    ds_read_b64_tr_b16 v[50:51], v6 offset:33280
    s_waitcnt lgkmcnt(4)
    v_mfma_f32_32x32x16_bf16 v[16:31], v[56:59], v[140:143], v[16:31]
    ds_read_b64_tr_b16 v[52:53], v7 offset:32768
    ds_read_b64_tr_b16 v[54:55], v7 offset:33280
    s_waitcnt lgkmcnt(4)
    v_mfma_f32_32x32x16_bf16 v[32:47], v[60:63], v[140:143], v[32:47]
    buffer_load_dwordx4 v[172:175], v12, s[16:19], s8 offen offset:3072 sc1
    s_add_u32 m0, s67, 0x3800
    s_mov_b32 s9, 0x6c000
    buffer_load_dwordx4 v13, s[20:23], s9 offen lds
    s_waitcnt vmcnt(15)
    ds_read_b64_tr_b16 v[56:57], v6 offset:34816
    ds_read_b64_tr_b16 v[58:59], v6 offset:35328
    s_waitcnt lgkmcnt(4)
    v_mfma_f32_32x32x16_bf16 v[16:31], v[48:51], v[144:147], v[16:31]
    ds_read_b64_tr_b16 v[60:61], v7 offset:34816
    ds_read_b64_tr_b16 v[62:63], v7 offset:35328
    s_waitcnt lgkmcnt(4)
    v_mfma_f32_32x32x16_bf16 v[32:47], v[52:55], v[144:147], v[32:47]
    s_mov_b32 s8, 0x6000
    buffer_load_dwordx4 v[176:179], v12, s[16:19], s8 offen offset:0 sc1
    s_waitcnt vmcnt(14)
    ds_read_b64_tr_b16 v[48:49], v6 offset:36864
    ds_read_b64_tr_b16 v[50:51], v6 offset:37376
    s_waitcnt lgkmcnt(4)
    v_mfma_f32_32x32x16_bf16 v[16:31], v[56:59], v[148:151], v[16:31]
    ds_read_b64_tr_b16 v[52:53], v7 offset:36864
    ds_read_b64_tr_b16 v[54:55], v7 offset:37376
    s_waitcnt lgkmcnt(4)
    v_mfma_f32_32x32x16_bf16 v[32:47], v[60:63], v[148:151], v[32:47]
    buffer_load_dwordx4 v[180:183], v12, s[16:19], s8 offen offset:1024 sc1
    s_waitcnt vmcnt(13)
    ds_read_b64_tr_b16 v[56:57], v6 offset:38912
    ds_read_b64_tr_b16 v[58:59], v6 offset:39424
    s_waitcnt lgkmcnt(4)
    v_mfma_f32_32x32x16_bf16 v[16:31], v[48:51], v[152:155], v[16:31]
    ds_read_b64_tr_b16 v[60:61], v7 offset:38912
    ds_read_b64_tr_b16 v[62:63], v7 offset:39424
    s_waitcnt lgkmcnt(4)
    v_mfma_f32_32x32x16_bf16 v[32:47], v[52:55], v[152:155], v[32:47]
    buffer_load_dwordx4 v[184:187], v12, s[16:19], s8 offen offset:2048 sc1
    s_waitcnt vmcnt(3)
    s_barrier
    ds_read_b64_tr_b16 v[48:49], v6 offset:0
    ds_read_b64_tr_b16 v[50:51], v6 offset:512
    s_waitcnt lgkmcnt(4)
    v_mfma_f32_32x32x16_bf16 v[16:31], v[56:59], v[156:159], v[16:31]
    ds_read_b64_tr_b16 v[52:53], v7 offset:0
    ds_read_b64_tr_b16 v[54:55], v7 offset:512
    s_waitcnt lgkmcnt(4)
    v_mfma_f32_32x32x16_bf16 v[32:47], v[60:63], v[156:159], v[32:47]
    buffer_load_dwordx4 v[188:191], v12, s[16:19], s8 offen offset:3072 sc1
    ds_read_b64_tr_b16 v[56:57], v6 offset:2048
    ds_read_b64_tr_b16 v[58:59], v6 offset:2560
    s_waitcnt lgkmcnt(4)
    v_mfma_f32_32x32x16_bf16 v[16:31], v[48:51], v[160:163], v[16:31]
    ds_read_b64_tr_b16 v[60:61], v7 offset:2048
    ds_read_b64_tr_b16 v[62:63], v7 offset:2560
    s_waitcnt lgkmcnt(4)
    v_mfma_f32_32x32x16_bf16 v[32:47], v[52:55], v[160:163], v[32:47]
    ds_read_b64_tr_b16 v[48:49], v6 offset:4096
    ds_read_b64_tr_b16 v[50:51], v6 offset:4608
    s_waitcnt lgkmcnt(4)
    v_mfma_f32_32x32x16_bf16 v[16:31], v[56:59], v[164:167], v[16:31]
    ds_read_b64_tr_b16 v[52:53], v7 offset:4096
    ds_read_b64_tr_b16 v[54:55], v7 offset:4608
    s_waitcnt lgkmcnt(4)
    v_mfma_f32_32x32x16_bf16 v[32:47], v[60:63], v[164:167], v[32:47]
    s_cmp_lg_u32 s100, 0
    s_cbranch_scc1 ifl_104
    s_mov_b32 s32, s38
    s_mov_b32 s33, s39
    s_mov_b32 s34, 0x180000
    s_mov_b32 s35, 0x20000
    s_mov_b32 s6, 0
    s_mul_i32 s7, s5, 18432
    s_add_u32 s6, s6, s7
    s_mul_i32 s7, s3, 2304
    s_add_u32 s6, s6, s7
    v_min_u32 v9, 17, v1
    v_lshl_add_u32 v9, v9, 7, s6
    buffer_load_dword v240, v9, s[32:35], 0 offen
    s_mov_b32 s20, s38
    s_mov_b32 s21, s39
    s_mov_b32 s22, 0x180000
    s_mov_b32 s23, 0x20000
    v_lshrrev_b32 v9, 3, v1
    s_mov_b32 s6, 3072
    v_mul_lo_u32 v209, v9, s6
    v_bfe_u32 v9, v1, 4, 1
    v_lshlrev_b32 v9, 2, v9
    v_and_b32 v10, 7, v1
    v_xor_b32 v9, v9, v10
    v_lshl_add_u32 v209, v9, 4, v209
    s_lshl_b32 s6, s11, 7
    v_add_u32 v209, s6, v209
    v_lshrrev_b32 v9, 3, v1
    v_lshrrev_b32 v10, 4, v1
    v_and_b32 v11, 7, v1
    v_xor_b32 v10, v10, v11
    v_lshlrev_b32 v10, 4, v10
    v_lshl_add_u32 v210, v9, 10, v10
    s_mul_i32 s6, s3, 3
    s_add_u32 s6, s6, 0
    s_lshl_b32 s56, s6, 10
    s_add_u32 s56, s56, 10240
    s_and_b32 s7, s6, 1
    s_lshl_b32 s7, s7, 5
    v_xor_b32 v200, s7, v209
    s_and_b32 s7, s6, 7
    s_mul_i32 s7, s7, 24576
    s_lshr_b32 s6, s6, 3
    s_lshl_b32 s6, s6, 10
    s_add_u32 s6, s6, s7
    v_add_u32 v200, s6, v200
    s_mul_i32 s6, s3, 3
    s_add_u32 s6, s6, 1
    s_lshl_b32 s57, s6, 10
    s_add_u32 s57, s57, 10240
    s_and_b32 s7, s6, 1
    s_lshl_b32 s7, s7, 5
    v_xor_b32 v201, s7, v209
    s_and_b32 s7, s6, 7
    s_mul_i32 s7, s7, 24576
    s_lshr_b32 s6, s6, 3
    s_lshl_b32 s6, s6, 10
    s_add_u32 s6, s6, s7
    v_add_u32 v201, s6, v201
    s_mul_i32 s6, s3, 3
    s_add_u32 s6, s6, 2
    s_lshl_b32 s58, s6, 10
    s_add_u32 s58, s58, 10240
    s_and_b32 s7, s6, 1
    s_lshl_b32 s7, s7, 5
    v_xor_b32 v202, s7, v209
    s_and_b32 s7, s6, 7
    s_mul_i32 s7, s7, 24576
    s_lshr_b32 s6, s6, 3
    s_lshl_b32 s6, s6, 10
    s_add_u32 s6, s6, s7
    v_add_u32 v202, s6, v202
ifl_104:
    ds_read_b64_tr_b16 v[56:57], v6 offset:6144
    ds_read_b64_tr_b16 v[58:59], v6 offset:6656
    s_waitcnt lgkmcnt(4)
    v_mfma_f32_32x32x16_bf16 v[16:31], v[48:51], v[168:171], v[16:31]
    ds_read_b64_tr_b16 v[60:61], v7 offset:6144
    ds_read_b64_tr_b16 v[62:63], v7 offset:6656
    s_waitcnt lgkmcnt(4)
    v_mfma_f32_32x32x16_bf16 v[32:47], v[52:55], v[168:171], v[32:47]
    ds_read_b64_tr_b16 v[48:49], v6 offset:8192
    ds_read_b64_tr_b16 v[50:51], v6 offset:8704
    s_waitcnt lgkmcnt(4)
    v_mfma_f32_32x32x16_bf16 v[16:31], v[56:59], v[172:175], v[16:31]
    ds_read_b64_tr_b16 v[52:53], v7 offset:8192
    ds_read_b64_tr_b16 v[54:55], v7 offset:8704
    s_waitcnt lgkmcnt(4)
    v_mfma_f32_32x32x16_bf16 v[32:47], v[60:63], v[172:175], v[32:47]
    s_waitcnt vmcnt(3)
    ds_read_b64_tr_b16 v[56:57], v6 offset:10240
    ds_read_b64_tr_b16 v[58:59], v6 offset:10752
    s_waitcnt lgkmcnt(4)
    v_mfma_f32_32x32x16_bf16 v[16:31], v[48:51], v[176:179], v[16:31]
    ds_read_b64_tr_b16 v[60:61], v7 offset:10240
    ds_read_b64_tr_b16 v[62:63], v7 offset:10752
    s_waitcnt lgkmcnt(4)
    v_mfma_f32_32x32x16_bf16 v[32:47], v[52:55], v[176:179], v[32:47]
    s_waitcnt vmcnt(2)
    ds_read_b64_tr_b16 v[48:49], v6 offset:12288
    ds_read_b64_tr_b16 v[50:51], v6 offset:12800
    s_waitcnt lgkmcnt(4)
    v_mfma_f32_32x32x16_bf16 v[16:31], v[56:59], v[180:183], v[16:31]
    ds_read_b64_tr_b16 v[52:53], v7 offset:12288
    ds_read_b64_tr_b16 v[54:55], v7 offset:12800
    s_waitcnt lgkmcnt(4)
    v_mfma_f32_32x32x16_bf16 v[32:47], v[60:63], v[180:183], v[32:47]
    s_waitcnt vmcnt(1)
    ds_read_b64_tr_b16 v[56:57], v6 offset:14336
    ds_read_b64_tr_b16 v[58:59], v6 offset:14848
    s_waitcnt lgkmcnt(4)
    v_mfma_f32_32x32x16_bf16 v[16:31], v[48:51], v[184:187], v[16:31]
    ds_read_b64_tr_b16 v[60:61], v7 offset:14336
    ds_read_b64_tr_b16 v[62:63], v7 offset:14848
    s_waitcnt lgkmcnt(4)
    v_mfma_f32_32x32x16_bf16 v[32:47], v[52:55], v[184:187], v[32:47]
    s_waitcnt vmcnt(0)
    s_waitcnt lgkmcnt(2)
    v_mfma_f32_32x32x16_bf16 v[16:31], v[56:59], v[188:191], v[16:31]
    s_waitcnt lgkmcnt(0)
    v_mfma_f32_32x32x16_bf16 v[32:47], v[60:63], v[188:191], v[32:47]
    s_barrier
    s_nop 9
    s_cmp_eq_u32 s12, 1
    s_cbranch_scc1 rv_107
    s_cmp_eq_u32 s12, 2
    s_cbranch_scc1 rv_108
    s_cmp_eq_u32 s12, 3
    s_cbranch_scc1 rv_109
rv_106:
    ds_write_b128 v8, v[24:27] offset:10240
    ds_write_b128 v8, v[28:31] offset:11264
    ds_write_b128 v8, v[32:35] offset:14336
    ds_write_b128 v8, v[36:39] offset:15360
    ds_write_b128 v8, v[40:43] offset:18432
    ds_write_b128 v8, v[44:47] offset:19456
    v_mov_b32 v48, v16
    v_mov_b32 v49, v17
    v_mov_b32 v50, v18
    v_mov_b32 v51, v19
    v_mov_b32 v52, v20
    v_mov_b32 v53, v21
    v_mov_b32 v54, v22
    v_mov_b32 v55, v23
    s_branch rdone_105
rv_107:
    ds_write_b128 v8, v[16:19] offset:0
    ds_write_b128 v8, v[20:23] offset:1024
    ds_write_b128 v8, v[32:35] offset:16384
    ds_write_b128 v8, v[36:39] offset:17408
    ds_write_b128 v8, v[40:43] offset:20480
    ds_write_b128 v8, v[44:47] offset:21504
    v_mov_b32 v48, v24
    v_mov_b32 v49, v25
    v_mov_b32 v50, v26
    v_mov_b32 v51, v27
    v_mov_b32 v52, v28
    v_mov_b32 v53, v29
    v_mov_b32 v54, v30
    v_mov_b32 v55, v31
    s_branch rdone_105
rv_108:
    ds_write_b128 v8, v[16:19] offset:2048
    ds_write_b128 v8, v[20:23] offset:3072
    ds_write_b128 v8, v[24:27] offset:6144
    ds_write_b128 v8, v[28:31] offset:7168
    ds_write_b128 v8, v[40:43] offset:22528
    ds_write_b128 v8, v[44:47] offset:23552
    v_mov_b32 v48, v32
    v_mov_b32 v49, v33
    v_mov_b32 v50, v34
    v_mov_b32 v51, v35
    v_mov_b32 v52, v36
    v_mov_b32 v53, v37
    v_mov_b32 v54, v38
    v_mov_b32 v55, v39
    s_branch rdone_105
rv_109:
    ds_write_b128 v8, v[16:19] offset:4096
    ds_write_b128 v8, v[20:23] offset:5120
    ds_write_b128 v8, v[24:27] offset:8192
    ds_write_b128 v8, v[28:31] offset:9216
    ds_write_b128 v8, v[32:35] offset:12288
    ds_write_b128 v8, v[36:39] offset:13312
    v_mov_b32 v48, v40
    v_mov_b32 v49, v41
    v_mov_b32 v50, v42
    v_mov_b32 v51, v43
    v_mov_b32 v52, v44
    v_mov_b32 v53, v45
    v_mov_b32 v54, v46
    v_mov_b32 v55, v47
rdone_105:
    s_mul_i32 s6, s12, 6144
    v_add_u32 v8, s6, v8
    s_cmp_lg_u32 s100, 0
    s_cbranch_scc1 ifl_110
    s_add_u32 m0, s56, 0x0
    s_nop 0
    buffer_load_dwordx4 v200, s[20:23], 0 offen lds
    s_add_u32 m0, s57, 0x0
    s_nop 0
    buffer_load_dwordx4 v201, s[20:23], 0 offen lds
    s_add_u32 m0, s58, 0x0
    s_nop 0
    buffer_load_dwordx4 v202, s[20:23], 0 offen lds
    s_add_u32 m0, s56, 0x8800
    s_mov_b32 s9, 0x30000
    buffer_load_dwordx4 v200, s[20:23], s9 offen lds
    s_add_u32 m0, s57, 0x8800
    s_mov_b32 s9, 0x30000
    buffer_load_dwordx4 v201, s[20:23], s9 offen lds
    s_add_u32 m0, s58, 0x8800
    s_mov_b32 s9, 0x30000
    buffer_load_dwordx4 v202, s[20:23], s9 offen lds
    s_add_u32 m0, s56, 0x11000
    s_mov_b32 s9, 0x60000
    buffer_load_dwordx4 v200, s[20:23], s9 offen lds
    s_add_u32 m0, s57, 0x11000
    s_mov_b32 s9, 0x60000
    buffer_load_dwordx4 v201, s[20:23], s9 offen lds
    s_add_u32 m0, s58, 0x11000
    s_mov_b32 s9, 0x60000
    buffer_load_dwordx4 v202, s[20:23], s9 offen lds
ifl_110:
    s_waitcnt lgkmcnt(0)
    s_barrier
    ds_read_b128 v[56:59], v8 offset:0
    ds_read_b128 v[60:63], v8 offset:1024
    ds_read_b128 v[64:67], v8 offset:2048
    ds_read_b128 v[68:71], v8 offset:3072
    ds_read_b128 v[72:75], v8 offset:4096
    ds_read_b128 v[76:79], v8 offset:5120
    v_lshlrev_b32 v16, 16, v248
    v_and_b32 v17, 0xffff0000, v248
    v_lshlrev_b32 v18, 16, v249
    v_and_b32 v19, 0xffff0000, v249
    v_lshlrev_b32 v20, 16, v250
    v_and_b32 v21, 0xffff0000, v250
    v_lshlrev_b32 v22, 16, v251
    v_and_b32 v23, 0xffff0000, v251
    v_pk_add_f32 v[48:49], v[48:49], v[16:17]
    v_pk_add_f32 v[50:51], v[50:51], v[18:19]
    v_pk_add_f32 v[52:53], v[52:53], v[20:21]
    v_pk_add_f32 v[54:55], v[54:55], v[22:23]
    s_waitcnt lgkmcnt(4)
    v_pk_add_f32 v[48:49], v[48:49], v[56:57]
    v_pk_add_f32 v[50:51], v[50:51], v[58:59]
    v_pk_add_f32 v[52:53], v[52:53], v[60:61]
    v_pk_add_f32 v[54:55], v[54:55], v[62:63]
    s_waitcnt lgkmcnt(2)
    v_pk_add_f32 v[48:49], v[48:49], v[64:65]
    v_pk_add_f32 v[50:51], v[50:51], v[66:67]
    v_pk_add_f32 v[52:53], v[52:53], v[68:69]
    v_pk_add_f32 v[54:55], v[54:55], v[70:71]
    s_waitcnt lgkmcnt(0)
    v_pk_add_f32 v[48:49], v[48:49], v[72:73]
    v_pk_add_f32 v[50:51], v[50:51], v[74:75]
    v_pk_add_f32 v[52:53], v[52:53], v[76:77]
    v_pk_add_f32 v[54:55], v[54:55], v[78:79]
    v_cvt_pk_bf16_f32 v248, v48, v49
    v_cvt_pk_bf16_f32 v249, v50, v51
    v_cvt_pk_bf16_f32 v250, v52, v53
    v_cvt_pk_bf16_f32 v251, v54, v55
    s_cmp_eq_u32 s54, 0
    s_cbranch_scc1 gs_111
    buffer_store_dwordx4 v[248:251], v5, s[28:31], 0 offen
    s_branch gd_112
gs_111:
    buffer_store_dwordx4 v[248:251], v5, s[28:31], 0 offen sc1
gd_112:
    s_cmp_lg_u32 s100, 0
    s_cbranch_scc1 end_all
    s_waitcnt vmcnt(0)
    s_barrier
    s_cmp_lg_u32 s3, 0
    s_cbranch_scc1 nopub_113
    s_lshl_b32 s6, s4, 7
    s_lshl_b32 s7, s5, 2
    s_add_u32 s6, s6, s7
    v_mov_b32 v2, s6
    v_mov_b32 v3, s55
    s_mov_b64 exec, 1
    s_add_u32 s8, s101, 3072
    s_cmp_eq_u32 s54, 0
    s_cbranch_scc1 gs_114
    buffer_store_dword v3, v2, s[96:99], s8 offen
    s_branch gd_115
gs_114:
    buffer_store_dword v3, v2, s[96:99], s8 offen sc1
gd_115:
    s_mov_b64 exec, -1
nopub_113:
    s_and_b32 s6, s66, 7
    s_cmp_lg_u32 s6, 7
    s_cbranch_scc1 nohalo_116
    s_lshl_b32 s6, s66, 15
    s_lshl_b32 s7, s4, 14
    s_sub_u32 s6, s6, s7
    s_add_u32 s6, s6, 0x4000
    v_subrev_u32 v9, s6, v5
    s_mov_b32 exec_lo, 0xffff0000
    s_mov_b32 exec_hi, 0xffff0000
    buffer_store_dwordx4 v[248:251], v9, s[24:27], 0 offen sc1
    s_mov_b64 exec, -1
    s_lshl_b32 s6, s4, 5
    s_lshl_b32 s7, s11, 2
    s_add_u32 s6, s6, s7
    s_add_u32 s6, s6, s12
    s_lshl_b32 s6, s6, 2
    s_add_u32 s6, s6, 7168
    v_mov_b32 v2, s6
    v_mov_b32 v3, s55
    s_waitcnt vmcnt(0)
    s_mov_b64 exec, 1
    buffer_store_dword v3, v2, s[96:99], 0 offen sc1
    s_mov_b64 exec, -1
nohalo_116:
    s_mov_b32 s100, 1
    s_mov_b32 s101, 4096
    s_branch layer
end_all:
    s_endpgm
.section .rodata,"a"
.p2align 6
.amdhsa_kernel interleave_layers__sliding_local_dilated__dense_activation_silu__prompt_kernel
  .amdhsa_next_free_vgpr 256
  .amdhsa_next_free_sgpr 102
  .amdhsa_accum_offset 256
  .amdhsa_group_segment_fixed_size 0
  .amdhsa_kernarg_size 72
  .amdhsa_user_sgpr_count 2
  .amdhsa_user_sgpr_kernarg_segment_ptr 1
  .amdhsa_system_sgpr_workgroup_id_x 1
.end_amdhsa_kernel
```
